```python
import torch

def _softmax(x, axis=-1):
    return torch.softmax(x, dim=axis)
def _gelu(x):
    return torch.nn.functional.gelu(x, approximate="tanh")
def _silu(x):
    return torch.nn.functional.silu(x)
def _sigmoid(x):
    return torch.sigmoid(x)
def _layernorm(x, axis=-1, eps=1e-5):
    m = x.mean(dim=axis, keepdim=True)
    v = x.var(dim=axis, keepdim=True, unbiased=False)
    return (x - m) / torch.sqrt(v + eps)
def _scatter_add(tgt, idx, src, axis=0):
    return tgt.clone().index_add_(axis, idx, src)
def _segment_sum(src, seg, n):
    out = torch.zeros((n,) + src.shape[1:], dtype=src.dtype)
    return out.index_add_(0, seg, src)
def _pad(x, pw):
    flat = tuple(v for pair in reversed(pw) for v in pair)
    return torch.nn.functional.pad(x, flat)

kernel_name = 'gather_scatter__edge_featured_mpnn_egc__graph'

def setup_inputs():

    _w = (lambda a: (lambda t: t.to(torch.bfloat16) if t.is_floating_point() else t)(torch.as_tensor(a)))
    N, deg, D, De = 25000, 16, 128, max(4, 1)
    E = N * deg
    return {
        "x": _w((lambda *s: torch.randn(*s, dtype=torch.bfloat16) * 0.1)(N, D)),
        "e_attr": _w((lambda *s: torch.randn(*s, dtype=torch.bfloat16) * 0.1)(E, De)),
        "src": _w((lambda lo, hi, *s: torch.randint(lo, hi, s))(0, N, E).to(torch.int64)),
        "dst": _w((lambda lo, hi, *s: torch.randint(lo, hi, s))(0, N, E).to(torch.int64)),
        "u_w": _w((lambda *s: torch.randn(*s, dtype=torch.bfloat16) * 0.05)(D, D)),
        "v_w": _w((lambda *s: torch.randn(*s, dtype=torch.bfloat16) * 0.05)(D, D)),
        "g_w": _w((lambda *s: torch.randn(*s, dtype=torch.bfloat16) * 0.1)(2 * D + De, D)),
    }

def reference(x, e_attr, src, dst, u_w, v_w, g_w):
    N, D = x.shape
    g_in = torch.concatenate([x[dst], x[src], e_attr], axis=-1)
    eta = _sigmoid(g_in @ g_w)
    hv = x @ v_w
    msg = eta * hv[src]
    agg = _segment_sum(msg, dst, N)
    return _silu(x @ u_w + agg)
```

```asm
; @launch grid=(256,1,1) block=(1024,1,1) lds=163840
.amdgcn_target "amdgcn-amd-amdhsa--gfx950"
.text
.globl gather_scatter__edge_featured_mpnn_egc__graph_kernel
.p2align 8
.type gather_scatter__edge_featured_mpnn_egc__graph_kernel,@function
gather_scatter__edge_featured_mpnn_egc__graph_kernel:
    s_cmp_ge_u32 s2, 256
    s_cbranch_scc1 K1_END2
    s_load_dwordx16 s[4:19], s[0:1], 0
    s_load_dwordx2 s[20:21], s[0:1], 72
    s_load_dwordx2 s[96:97], s[0:1], 64
    v_lshrrev_b32 v2, 6, v0
    v_and_b32 v1, 63, v0
    v_readfirstlane_b32 s22, v2
    s_mov_b32 s98, 256
    s_mov_b32 s99, 0x20000
    s_and_b32 s23, s2, 3
    s_lshr_b32 s25, s2, 2
    s_and_b32 s24, s25, 1
    s_lshl_b32 s24, s24, 5
    s_lshr_b32 s26, s2, 3
    s_lshl_b32 s27, s2, 3
    s_and_b32 s27, s27, 16
    s_xor_b32 s26, s26, s27
    s_or_b32 s24, s24, s26
    s_mov_b32 s29, s2
    s_mul_i32 s64, s24, 100096
    s_and_b32 s27, s2, 0x81
    s_cmp_eq_u32 s27, 0x80
    s_cselect_b32 s65, 1, 0
    v_lshlrev_b32 v2, 4, v0
    v_lshlrev_b32 v3, 5, v0
    v_lshrrev_b32 v4, 4, v1
    v_and_b32 v5, 15, v1
    v_xor_b32 v6, v5, v4
    v_lshlrev_b32 v6, 4, v6
    v_lshl_add_u32 v40, v4, 8, v6
    v_xor_b32 v41, 64, v40
    v_xor_b32 v42, 0x80, v40
    v_xor_b32 v43, 0xc0, v40
    v_lshrrev_b32 v6, 1, v5
    v_xor_b32 v6, v6, v4
    v_lshlrev_b32 v6, 5, v6
    v_lshl_add_u32 v6, v4, 8, v6
    v_and_b32 v7, 1, v1
    v_lshl_add_u32 v44, v7, 4, v6
    v_xor_b32 v45, 0x80, v44
    v_lshrrev_b32 v6, 2, v1
    v_lshlrev_b32 v6, 8, v6
    v_and_b32 v7, 3, v1
    v_lshrrev_b32 v8, 4, v1
    v_and_b32 v8, 2, v8
    v_xor_b32 v7, v7, v8
    v_lshl_add_u32 v46, v7, 4, v6
    s_waitcnt lgkmcnt(0)
    s_mov_b32 s48, s4
    s_mov_b32 s49, s5
    s_mov_b32 s50, 6400000
    s_mov_b32 s51, 0x20000
    s_cmp_ge_u32 s2, 128
    s_cbranch_scc1 K1_TB
    s_cmp_ge_u32 s29, 125
    s_cbranch_scc1 K1_NOEDGE
    s_cmp_ge_u32 s22, 13
    s_cbranch_scc1 K1_NOEDGE
    s_mov_b32 s32, s10
    s_mov_b32 s33, s11
    s_mov_b32 s34, 1600000
    s_mov_b32 s35, 0x20000
    s_mov_b32 s36, s8
    s_mov_b32 s37, s9
    s_mov_b32 s38, 1600000
    s_mov_b32 s39, 0x20000
    s_mov_b32 s40, s6
    s_mov_b32 s41, s7
    s_mov_b32 s42, 3200000
    s_mov_b32 s43, 0x20000
    v_cmp_gt_u32 vcc, 800, v0
    s_mul_i32 s25, s29, 12800
    s_mul_i32 s26, s29, 25600
    s_mov_b64 s[30:31], vcc
    s_mov_b64 exec, vcc
    buffer_load_dwordx4 v[16:19], v2, s[32:35], s25 offen nt
    buffer_load_dwordx4 v[20:23], v2, s[36:39], s25 offen nt
    buffer_load_dwordx4 v[24:27], v3, s[40:43], s26 offen nt
    buffer_load_dwordx4 v[28:31], v3, s[40:43], s26 offen offset:16 nt
    s_mov_b64 exec, -1
K1_NOEDGE:
    s_mov_b32 s44, s20
    s_mov_b32 s45, s21
    s_mov_b32 s46, 42991616
    s_mov_b32 s47, 0x20000
    v_lshlrev_b32 v6, 2, v1
    v_add_u32 v6, 118784, v6
    v_mov_b32 v7, 0
    v_mov_b32 v12, 119808
    s_cmp_lg_u32 s22, 0
    s_cbranch_scc1 K1_P1
    ds_write_b32 v6, v7
    ds_write_b32 v6, v7 offset:256
    ds_write_b32 v6, v7 offset:1024
    s_waitcnt lgkmcnt(0)
K1_P1:
    s_barrier
    s_cmp_lt_u32 s22, 13
    s_cbranch_scc1 K1_PW
    s_sub_u32 s66, s22, 13
K1_LA1:
    s_lshl_b32 s25, s66, 10
    s_add_u32 s25, s25, 102400
    s_mov_b32 m0, s25
    s_and_b32 s26, s66, 7
    s_lshl_b32 s26, s26, 12
    s_lshl_b32 s25, s23, 6
    s_add_u32 s26, s26, s25
    s_cmp_lt_u32 s66, 8
    s_cselect_b32 s52, s16, s12
    s_cselect_b32 s53, s17, s13
    s_mov_b32 s54, 32768
    s_mov_b32 s55, 0x20000
    buffer_load_dwordx4 v46, s[52:55], s26 offen lds
    s_add_u32 s66, s66, 3
    s_cmp_lt_u32 s66, 16
    s_cbranch_scc1 K1_LA1
    s_sub_u32 s66, s22, 13
    s_lshl_b32 s25, s66, 12
    s_mov_b32 m0, s25
    s_sub_u32 s26, s66, s65
    s_cselect_b32 s26, 24, s26
    s_lshl_b32 s26, s26, 12
    s_add_u32 s26, s26, s64
    buffer_load_dwordx4 v40, s[48:51], s26 offen offset:0 lds
    buffer_load_dwordx4 v41, s[48:51], s26 offen offset:1024 lds
    buffer_load_dwordx4 v42, s[48:51], s26 offen offset:2048 lds
    buffer_load_dwordx4 v43, s[48:51], s26 offen offset:3072 lds
    s_add_u32 s66, s66, 3
    s_lshl_b32 s25, s66, 12
    s_mov_b32 m0, s25
    s_sub_u32 s26, s66, s65
    s_cselect_b32 s26, 24, s26
    s_lshl_b32 s26, s26, 12
    s_add_u32 s26, s26, s64
    buffer_load_dwordx4 v40, s[48:51], s26 offen offset:0 lds
    buffer_load_dwordx4 v41, s[48:51], s26 offen offset:1024 lds
    buffer_load_dwordx4 v42, s[48:51], s26 offen offset:2048 lds
    buffer_load_dwordx4 v43, s[48:51], s26 offen offset:3072 lds
    s_add_u32 s66, s66, 3
    v_mov_b32 v7, 1
    s_waitcnt vmcnt(8)
    s_mov_b64 exec, 1
    ds_add_u32 v12, v7 offset:12
    s_mov_b64 exec, -1
K1_LA2:
    s_lshl_b32 s25, s66, 12
    s_mov_b32 m0, s25
    s_sub_u32 s26, s66, s65
    s_cselect_b32 s26, 24, s26
    s_lshl_b32 s26, s26, 12
    s_add_u32 s26, s26, s64
    buffer_load_dwordx4 v40, s[48:51], s26 offen offset:0 lds
    buffer_load_dwordx4 v41, s[48:51], s26 offen offset:1024 lds
    buffer_load_dwordx4 v42, s[48:51], s26 offen offset:2048 lds
    buffer_load_dwordx4 v43, s[48:51], s26 offen offset:3072 lds
    s_add_u32 s66, s66, 3
    s_cmp_lt_u32 s66, 25
    s_cbranch_scc1 K1_LA2
    s_branch K1_AUA
K1_PW:
    s_cmp_ge_u32 s29, 125
    s_cbranch_scc1 K1_AUA
    s_mov_b32 s25, 85817
    s_mov_b32 s26, 4294966905
    v_mov_b32 v7, 1
    s_mov_b64 exec, s[30:31]
    s_waitcnt vmcnt(3)
    v_mul_u32_u24 v32, s25, v16
    v_mul_u32_u24 v33, s25, v17
    v_mul_u32_u24 v34, s25, v18
    v_mul_u32_u24 v35, s25, v19
    v_lshrrev_b32 v32, 25, v32
    v_lshrrev_b32 v33, 25, v33
    v_lshrrev_b32 v34, 25, v34
    v_lshrrev_b32 v35, 25, v35
    v_mad_i32_i24 v16, v32, s26, v16
    v_mad_i32_i24 v17, v33, s26, v17
    v_mad_i32_i24 v18, v34, s26, v18
    v_mad_i32_i24 v19, v35, s26, v19
    v_lshlrev_b32 v32, 2, v32
    v_lshlrev_b32 v33, 2, v33
    v_lshlrev_b32 v34, 2, v34
    v_lshlrev_b32 v35, 2, v35
    v_add_u32 v32, 118784, v32
    v_add_u32 v33, 118784, v33
    v_add_u32 v34, 118784, v34
    v_add_u32 v35, 118784, v35
    ds_add_rtn_u32 v36, v32, v7
    ds_add_rtn_u32 v37, v33, v7
    ds_add_rtn_u32 v38, v34, v7
    ds_add_rtn_u32 v39, v35, v7
    v_lshlrev_b32 v16, 2, v16
    v_lshlrev_b32 v17, 2, v17
    v_lshlrev_b32 v18, 2, v18
    v_lshlrev_b32 v19, 2, v19
    s_waitcnt vmcnt(2)
    v_lshl_or_b32 v20, v20, 16, v16
    v_lshl_or_b32 v21, v21, 16, v17
    v_lshl_or_b32 v22, v22, 16, v18
    v_lshl_or_b32 v23, v23, 16, v19
    s_waitcnt lgkmcnt(0)
    s_mov_b64 exec, 1
    ds_add_u32 v12, v7 offset:4
    s_mov_b64 exec, -1
K1_SB2:
    ds_read_b32 v13, v12 offset:4
    s_waitcnt lgkmcnt(0)
    v_cmp_gt_u32 vcc, 13, v13
    s_cbranch_vccnz K1_SB2
    ds_read_b32 v8, v6
    s_waitcnt lgkmcnt(0)
    v_mov_b32 v9, v8
    s_nop 1
    v_add_u32_dpp v9, v9, v9 row_shr:1 row_mask:0xf bank_mask:0xf bound_ctrl:0
    s_nop 1
    v_add_u32_dpp v9, v9, v9 row_shr:2 row_mask:0xf bank_mask:0xf bound_ctrl:0
    s_nop 1
    v_add_u32_dpp v9, v9, v9 row_shr:4 row_mask:0xf bank_mask:0xf bound_ctrl:0
    s_nop 1
    v_add_u32_dpp v9, v9, v9 row_shr:8 row_mask:0xf bank_mask:0xf bound_ctrl:0
    s_nop 1
    v_add_u32_dpp v9, v9, v9 row_bcast:15 row_mask:0xa bank_mask:0xf
    s_nop 1
    v_add_u32_dpp v9, v9, v9 row_bcast:31 row_mask:0xc bank_mask:0xf
    v_sub_u32 v9, v9, v8
    ds_write_b32 v6, v9 offset:512
    v_lshl_or_b32 v8, v8, 16, v9
    s_mov_b64 exec, s[30:31]
    ds_read_b32 v32, v32 offset:512
    ds_read_b32 v33, v33 offset:512
    ds_read_b32 v34, v34 offset:512
    ds_read_b32 v35, v35 offset:512
    s_waitcnt lgkmcnt(0)
    v_add_u32 v32, v32, v36
    v_add_u32 v33, v33, v37
    v_add_u32 v34, v34, v38
    v_add_u32 v35, v35, v39
    v_lshlrev_b32 v36, 2, v32
    v_lshlrev_b32 v32, 3, v32
    v_lshlrev_b32 v37, 2, v33
    v_lshlrev_b32 v33, 3, v33
    v_lshlrev_b32 v38, 2, v34
    v_lshlrev_b32 v34, 3, v34
    v_lshlrev_b32 v39, 2, v35
    v_lshlrev_b32 v35, 3, v35
    v_add_u32 v36, 120832, v36
    v_add_u32 v32, 133632, v32
    v_add_u32 v37, 120832, v37
    v_add_u32 v33, 133632, v33
    v_add_u32 v38, 120832, v38
    v_add_u32 v34, 133632, v34
    v_add_u32 v39, 120832, v39
    v_add_u32 v35, 133632, v35
    ds_write_b32 v36, v20
    ds_write_b32 v37, v21
    ds_write_b32 v38, v22
    ds_write_b32 v39, v23
    s_waitcnt vmcnt(0)
    ds_write_b64 v32, v[24:25]
    ds_write_b64 v33, v[26:27]
    ds_write_b64 v34, v[28:29]
    ds_write_b64 v35, v[30:31]
    v_or3_b32 v16, v24, v25, v26
    v_or3_b32 v17, v27, v28, v29
    v_or3_b32 v16, v30, v31, v16
    v_or_b32 v16, v16, v17
    v_and_b32 v16, 0x40004000, v16
    v_cmp_ne_u32 vcc, 0, v16
    s_cmp_lg_u64 vcc, 0
    s_cselect_b32 s94, 0x101, 1
    s_waitcnt lgkmcnt(0)
    s_mov_b64 exec, 1
    ds_add_u32 v12, v7 offset:8
    s_mov_b64 exec, -1
K1_SB3:
    ds_read_b32 v13, v12 offset:8
    s_waitcnt lgkmcnt(0)
    v_cmp_gt_u32 vcc, 13, v13
    s_cbranch_vccnz K1_SB3
    s_mov_b64 exec, s[30:31]
    v_add_u32 v6, 120832, v2
    ds_read_b128 v[16:19], v6
    ds_read_b128 v[20:23], v6 offset:12800
    ds_read_b128 v[24:27], v6 offset:25600
    s_mul_i32 s25, s29, 12800
    s_add_u32 s25, s25, 33554432
    s_mul_i32 s26, s29, 25600
    s_add_u32 s26, s26, 35651584
    s_add_u32 s27, s26, 12800
    s_waitcnt lgkmcnt(2)
    buffer_store_dwordx4 v[16:19], v2, s[44:47], s25 offen sc1
    s_waitcnt lgkmcnt(1)
    buffer_store_dwordx4 v[20:23], v2, s[44:47], s26 offen sc1
    s_waitcnt lgkmcnt(0)
    buffer_store_dwordx4 v[24:27], v2, s[44:47], s27 offen sc1
    s_mov_b64 exec, -1
    s_cmp_lg_u32 s22, 0
    s_cbranch_scc1 K1_P2B
    v_lshlrev_b32 v9, 2, v1
    s_lshl_b32 s25, s29, 8
    s_add_u32 s25, s25, 41943040
    buffer_store_dword v8, v9, s[44:47], s25 offen sc1
K1_P2B:
    v_mov_b32 v15, s94
    s_waitcnt vmcnt(0)
    s_mov_b64 exec, 1
    ds_add_rtn_u32 v14, v12, v15
    s_waitcnt lgkmcnt(0)
    v_add_u32 v14, v14, v15
    v_and_b32 v15, 0xff, v14
    v_cmp_eq_u32 vcc, 13, v15
    s_cbranch_vccz K1_NOR2
    v_lshrrev_b32 v14, 8, v14
    v_lshl_or_b32 v14, v14, 16, 1
    v_mov_b32 v15, v14
    buffer_atomic_add v15, off, s[96:99], 0 sc0 sc1
    s_waitcnt vmcnt(0)
    v_add_u32 v15, v15, v14
    v_and_b32 v14, 0xffff, v15
    v_cmp_eq_u32 vcc, 125, v14
    s_cbranch_vccz K1_NOR2
    buffer_store_dword v15, off, s[96:99], 0 offset:192 sc1
K1_NOR2:
    s_mov_b64 exec, -1
K1_AUA:
    ds_read_b32 v13, v12 offset:12
    s_waitcnt lgkmcnt(0)
    v_cmp_gt_u32 vcc, 3, v13
    s_cbranch_vccnz K1_AUA
    s_branch K1_AU
K1_TB:
    s_add_u32 s25, s16, 32768
    s_addc_u32 s26, s17, 0
    s_cmp_lt_u32 s22, 8
    s_cselect_b32 s56, s25, s14
    s_cselect_b32 s57, s26, s15
    s_mov_b32 s58, 32768
    s_mov_b32 s59, 0x20000
    s_lshl_b32 s25, s22, 12
    s_add_u32 s26, s25, 98304
    s_mov_b32 m0, s26
    s_and_b32 s25, s25, 0x7fff
    buffer_load_dwordx4 v44, s[56:59], s25 offen offset:0 lds
    buffer_load_dwordx4 v44, s[56:59], s25 offen offset:1024 lds
    buffer_load_dwordx4 v45, s[56:59], s25 offen offset:2048 lds
    buffer_load_dwordx4 v45, s[56:59], s25 offen offset:3072 lds
    s_mov_b32 s44, s20
    s_mov_b32 s45, s21
    s_mov_b32 s46, 42991616
    s_mov_b32 s47, 0x20000
    s_cmp_ge_u32 s22, 13
    s_cbranch_scc1 K1_B0
    s_lshl_b32 s66, s22, 1
    s_add_u32 s66, s66, 1
    s_cmp_eq_u32 s22, 12
    s_cselect_b32 s66, 0, s66
    s_lshl_b32 s25, s66, 12
    s_mov_b32 m0, s25
    s_sub_u32 s26, s66, s65
    s_cselect_b32 s26, 24, s26
    s_lshl_b32 s26, s26, 12
    s_add_u32 s26, s26, s64
    buffer_load_dwordx4 v40, s[48:51], s26 offen offset:0 lds
    buffer_load_dwordx4 v41, s[48:51], s26 offen offset:1024 lds
    buffer_load_dwordx4 v42, s[48:51], s26 offen offset:2048 lds
    buffer_load_dwordx4 v43, s[48:51], s26 offen offset:3072 lds
K1_B0:
    s_and_b32 s62, s22, 3
    s_lshr_b32 s63, s22, 2
    v_lshrrev_b32 v2, 4, v1
    v_and_b32 v3, 15, v1
    v_lshrrev_b32 v48, 2, v3
    v_and_b32 v49, 1, v2
    v_lshl_or_b32 v49, v49, 2, v48
    s_lshl_b32 s25, s62, 1
    v_xor_b32 v49, s25, v49
    v_lshlrev_b32 v49, 5, v49
    v_lshl_add_u32 v48, v2, 3, v48
    v_lshl_add_u32 v48, v48, 8, v49
    v_and_b32 v49, 3, v1
    v_lshl_add_u32 v48, v49, 3, v48
    v_add_u32 v48, 98304, v48
    v_xor_b32 v49, 32, v48
    v_and_b32 v10, 7, v3
    v_xor_b32 v10, v10, v2
    v_lshlrev_b32 v10, 4, v10
    v_lshl_add_u32 v10, v3, 7, v10
    s_lshl_b32 s25, s22, 11
    s_add_u32 s25, s25, 131072
    v_add_u32 v10, s25, v10
    v_xor_b32 v0, 64, v10
    v_lshlrev_b32 v2, 4, v1
    v_add_u32 v2, s25, v2
    v_lshrrev_b32 v3, 3, v1
    v_and_b32 v28, 7, v1
    v_xor_b32 v28, v28, v3
    v_lshlrev_b32 v28, 4, v28
    v_lshl_add_u32 v3, v3, 7, v28
    s_mov_b32 s60, 0xbfb8aa3b
    s_cmp_ge_u32 s22, 13
    s_cbranch_scc1 K1_B1
    s_waitcnt vmcnt(4)
    s_branch K1_B2
K1_B1:
    s_waitcnt vmcnt(0)
K1_B2:
    s_barrier
    ds_read_b64_tr_b16 v[64:65], v48 offset:0
    ds_read_b64_tr_b16 v[66:67], v48 offset:1024
    ds_read_b64_tr_b16 v[80:81], v49 offset:0
    ds_read_b64_tr_b16 v[82:83], v49 offset:1024
    ds_read_b64_tr_b16 v[96:97], v48 offset:32768
    ds_read_b64_tr_b16 v[98:99], v48 offset:33792
    ds_read_b64_tr_b16 v[112:113], v49 offset:32768
    ds_read_b64_tr_b16 v[114:115], v49 offset:33792
    ds_read_b64_tr_b16 v[68:69], v48 offset:8192
    ds_read_b64_tr_b16 v[70:71], v48 offset:9216
    ds_read_b64_tr_b16 v[84:85], v49 offset:8192
    ds_read_b64_tr_b16 v[86:87], v49 offset:9216
    ds_read_b64_tr_b16 v[100:101], v48 offset:40960
    ds_read_b64_tr_b16 v[102:103], v48 offset:41984
    ds_read_b64_tr_b16 v[116:117], v49 offset:40960
    ds_read_b64_tr_b16 v[118:119], v49 offset:41984
    ds_read_b64_tr_b16 v[72:73], v48 offset:16384
    ds_read_b64_tr_b16 v[74:75], v48 offset:17408
    ds_read_b64_tr_b16 v[88:89], v49 offset:16384
    ds_read_b64_tr_b16 v[90:91], v49 offset:17408
    ds_read_b64_tr_b16 v[104:105], v48 offset:49152
    ds_read_b64_tr_b16 v[106:107], v48 offset:50176
    ds_read_b64_tr_b16 v[120:121], v49 offset:49152
    ds_read_b64_tr_b16 v[122:123], v49 offset:50176
    ds_read_b64_tr_b16 v[76:77], v48 offset:24576
    ds_read_b64_tr_b16 v[78:79], v48 offset:25600
    ds_read_b64_tr_b16 v[92:93], v49 offset:24576
    ds_read_b64_tr_b16 v[94:95], v49 offset:25600
    ds_read_b64_tr_b16 v[108:109], v48 offset:57344
    ds_read_b64_tr_b16 v[110:111], v48 offset:58368
    ds_read_b64_tr_b16 v[124:125], v49 offset:57344
    ds_read_b64_tr_b16 v[126:127], v49 offset:58368
    s_waitcnt lgkmcnt(0)
    s_barrier
    s_lshl_b32 s25, s22, 10
    s_add_u32 s25, s25, 102400
    s_mov_b32 m0, s25
    s_and_b32 s26, s22, 7
    s_lshl_b32 s26, s26, 12
    s_lshl_b32 s25, s23, 6
    s_add_u32 s26, s26, s25
    s_cmp_lt_u32 s22, 8
    s_cselect_b32 s52, s16, s12
    s_cselect_b32 s53, s17, s13
    s_mov_b32 s54, 32768
    s_mov_b32 s55, 0x20000
    buffer_load_dwordx4 v46, s[52:55], s26 offen lds
    v_lshrrev_b32 v4, 4, v1
    v_and_b32 v5, 15, v1
    v_xor_b32 v4, v4, v5
    v_lshlrev_b32 v4, 4, v4
    v_lshl_add_u32 v5, v5, 8, v4
    s_lshl_b32 s67, s63, 1
    s_add_u32 s67, s67, 1
    s_mul_i32 s61, s62, 3205120
    s_lshr_b32 s25, s64, 1
    s_add_u32 s61, s61, s25
    s_sub_u32 s25, s67, s65
    s_lshl_b32 s25, s25, 11
    s_add_u32 s61, s61, s25
    v_mov_b32 v4, 0
    s_waitcnt vmcnt(0)
    s_barrier
    s_cmp_ge_u32 s22, 12
    s_cbranch_scc1 K1_B3
    s_lshl_b32 s66, s22, 1
    s_add_u32 s66, s66, 2
    s_lshl_b32 s25, s66, 12
    s_mov_b32 m0, s25
    s_sub_u32 s26, s66, s65
    s_cselect_b32 s26, 24, s26
    s_lshl_b32 s26, s26, 12
    s_add_u32 s26, s26, s64
    buffer_load_dwordx4 v40, s[48:51], s26 offen offset:0 lds
    buffer_load_dwordx4 v41, s[48:51], s26 offen offset:1024 lds
    buffer_load_dwordx4 v42, s[48:51], s26 offen offset:2048 lds
    buffer_load_dwordx4 v43, s[48:51], s26 offen offset:3072 lds
K1_B3:
    s_lshl_b32 s25, s67, 12
    v_add_u32 v6, s25, v5
    v_xor_b32 v7, 64, v6
    v_xor_b32 v8, 0x80, v6
    v_xor_b32 v9, 0xc0, v6
    ds_read_b128 v[32:35], v6
    ds_read_b128 v[36:39], v7
    ds_read_b128 v[40:43], v8
    ds_read_b128 v[44:47], v9
    s_add_u32 s67, s67, 8
    s_waitcnt lgkmcnt(0)
    v_mfma_f32_16x16x32_bf16 v[16:19], v[64:67], v[32:35], 0
    v_mfma_f32_16x16x32_bf16 v[20:23], v[80:83], v[32:35], 0
    v_mfma_f32_16x16x32_bf16 v[24:27], v[96:99], v[32:35], 0
    v_mfma_f32_16x16x32_bf16 v[28:31], v[112:115], v[32:35], 0
    s_lshl_b32 s25, s67, 12
    v_add_u32 v6, s25, v5
    v_xor_b32 v7, 64, v6
    v_xor_b32 v8, 0x80, v6
    v_xor_b32 v9, 0xc0, v6
    ds_read_b128 v[48:51], v6
    ds_read_b128 v[52:55], v7
    ds_read_b128 v[56:59], v8
    ds_read_b128 v[60:63], v9
    v_mfma_f32_16x16x32_bf16 v[16:19], v[68:71], v[36:39], v[16:19]
    v_mfma_f32_16x16x32_bf16 v[20:23], v[84:87], v[36:39], v[20:23]
    v_mfma_f32_16x16x32_bf16 v[24:27], v[100:103], v[36:39], v[24:27]
    v_mfma_f32_16x16x32_bf16 v[28:31], v[116:119], v[36:39], v[28:31]
    v_mfma_f32_16x16x32_bf16 v[16:19], v[72:75], v[40:43], v[16:19]
    v_mfma_f32_16x16x32_bf16 v[20:23], v[88:91], v[40:43], v[20:23]
    v_mfma_f32_16x16x32_bf16 v[24:27], v[104:107], v[40:43], v[24:27]
    v_mfma_f32_16x16x32_bf16 v[28:31], v[120:123], v[40:43], v[28:31]
    v_mfma_f32_16x16x32_bf16 v[16:19], v[76:79], v[44:47], v[16:19]
    v_mfma_f32_16x16x32_bf16 v[20:23], v[92:95], v[44:47], v[20:23]
    v_mfma_f32_16x16x32_bf16 v[24:27], v[108:111], v[44:47], v[24:27]
    v_mfma_f32_16x16x32_bf16 v[28:31], v[124:127], v[44:47], v[28:31]
    s_nop 7
    v_max3_f32 v4, abs(v16), abs(v17), v4
    v_max3_f32 v4, abs(v18), abs(v19), v4
    v_max3_f32 v4, abs(v20), abs(v21), v4
    v_max3_f32 v4, abs(v22), abs(v23), v4
    v_max3_f32 v4, abs(v24), abs(v25), v4
    v_max3_f32 v4, abs(v26), abs(v27), v4
    v_max3_f32 v4, abs(v28), abs(v29), v4
    v_max3_f32 v4, abs(v30), abs(v31), v4
    v_fma_mixlo_f16 v24, v16, s60, 0
    v_fma_mixlo_f16 v25, v17, s60, 0
    v_fma_mixlo_f16 v26, v18, s60, 0
    v_fma_mixlo_f16 v27, v19, s60, 0
    v_fma_mixlo_f16 v28, v20, s60, 0
    v_fma_mixlo_f16 v29, v21, s60, 0
    v_fma_mixlo_f16 v30, v22, s60, 0
    v_fma_mixlo_f16 v31, v23, s60, 0
    ds_write_b128 v10, v[24:27]
    ds_write_b128 v0, v[28:31]
    ds_read_b128 v[12:15], v2
    ds_read_b128 v[16:19], v2 offset:1024
    s_waitcnt lgkmcnt(1)
    buffer_store_dwordx4 v[12:15], v3, s[44:47], s61 offen sc1
    s_waitcnt lgkmcnt(0)
    buffer_store_dwordx4 v[16:19], v3, s[44:47], s61 offen offset:1024 sc1
    s_add_u32 s61, s61, 16384
    s_nop 1
    s_add_u32 s67, s67, 8
    s_waitcnt lgkmcnt(0)
    v_mfma_f32_16x16x32_bf16 v[16:19], v[64:67], v[48:51], 0
    v_mfma_f32_16x16x32_bf16 v[20:23], v[80:83], v[48:51], 0
    v_mfma_f32_16x16x32_bf16 v[24:27], v[96:99], v[48:51], 0
    v_mfma_f32_16x16x32_bf16 v[28:31], v[112:115], v[48:51], 0
    s_lshl_b32 s25, s67, 12
    v_add_u32 v6, s25, v5
    v_xor_b32 v7, 64, v6
    v_xor_b32 v8, 0x80, v6
    v_xor_b32 v9, 0xc0, v6
    ds_read_b128 v[32:35], v6
    ds_read_b128 v[36:39], v7
    ds_read_b128 v[40:43], v8
    ds_read_b128 v[44:47], v9
    v_mfma_f32_16x16x32_bf16 v[16:19], v[68:71], v[52:55], v[16:19]
    v_mfma_f32_16x16x32_bf16 v[20:23], v[84:87], v[52:55], v[20:23]
    v_mfma_f32_16x16x32_bf16 v[24:27], v[100:103], v[52:55], v[24:27]
    v_mfma_f32_16x16x32_bf16 v[28:31], v[116:119], v[52:55], v[28:31]
    v_mfma_f32_16x16x32_bf16 v[16:19], v[72:75], v[56:59], v[16:19]
    v_mfma_f32_16x16x32_bf16 v[20:23], v[88:91], v[56:59], v[20:23]
    v_mfma_f32_16x16x32_bf16 v[24:27], v[104:107], v[56:59], v[24:27]
    v_mfma_f32_16x16x32_bf16 v[28:31], v[120:123], v[56:59], v[28:31]
    v_mfma_f32_16x16x32_bf16 v[16:19], v[76:79], v[60:63], v[16:19]
    v_mfma_f32_16x16x32_bf16 v[20:23], v[92:95], v[60:63], v[20:23]
    v_mfma_f32_16x16x32_bf16 v[24:27], v[108:111], v[60:63], v[24:27]
    v_mfma_f32_16x16x32_bf16 v[28:31], v[124:127], v[60:63], v[28:31]
    s_nop 7
    v_max3_f32 v4, abs(v16), abs(v17), v4
    v_max3_f32 v4, abs(v18), abs(v19), v4
    v_max3_f32 v4, abs(v20), abs(v21), v4
    v_max3_f32 v4, abs(v22), abs(v23), v4
    v_max3_f32 v4, abs(v24), abs(v25), v4
    v_max3_f32 v4, abs(v26), abs(v27), v4
    v_max3_f32 v4, abs(v28), abs(v29), v4
    v_max3_f32 v4, abs(v30), abs(v31), v4
    v_fma_mixlo_f16 v24, v16, s60, 0
    v_fma_mixlo_f16 v25, v17, s60, 0
    v_fma_mixlo_f16 v26, v18, s60, 0
    v_fma_mixlo_f16 v27, v19, s60, 0
    v_fma_mixlo_f16 v28, v20, s60, 0
    v_fma_mixlo_f16 v29, v21, s60, 0
    v_fma_mixlo_f16 v30, v22, s60, 0
    v_fma_mixlo_f16 v31, v23, s60, 0
    ds_write_b128 v10, v[24:27]
    ds_write_b128 v0, v[28:31]
    ds_read_b128 v[12:15], v2
    ds_read_b128 v[16:19], v2 offset:1024
    s_waitcnt lgkmcnt(1)
    buffer_store_dwordx4 v[12:15], v3, s[44:47], s61 offen sc1
    s_waitcnt lgkmcnt(0)
    buffer_store_dwordx4 v[16:19], v3, s[44:47], s61 offen offset:1024 sc1
    s_add_u32 s61, s61, 16384
    s_nop 1
    s_mov_b32 s67, 0
    s_waitcnt lgkmcnt(0)
    v_mfma_f32_16x16x32_bf16 v[16:19], v[64:67], v[32:35], 0
    v_mfma_f32_16x16x32_bf16 v[20:23], v[80:83], v[32:35], 0
    v_mfma_f32_16x16x32_bf16 v[24:27], v[96:99], v[32:35], 0
    v_mfma_f32_16x16x32_bf16 v[28:31], v[112:115], v[32:35], 0
    s_lshl_b32 s25, s67, 12
    v_add_u32 v6, s25, v5
    v_xor_b32 v7, 64, v6
    v_xor_b32 v8, 0x80, v6
    v_xor_b32 v9, 0xc0, v6
    ds_read_b128 v[48:51], v6
    ds_read_b128 v[52:55], v7
    ds_read_b128 v[56:59], v8
    ds_read_b128 v[60:63], v9
    v_mfma_f32_16x16x32_bf16 v[16:19], v[68:71], v[36:39], v[16:19]
    v_mfma_f32_16x16x32_bf16 v[20:23], v[84:87], v[36:39], v[20:23]
    v_mfma_f32_16x16x32_bf16 v[24:27], v[100:103], v[36:39], v[24:27]
    v_mfma_f32_16x16x32_bf16 v[28:31], v[116:119], v[36:39], v[28:31]
    v_mfma_f32_16x16x32_bf16 v[16:19], v[72:75], v[40:43], v[16:19]
    v_mfma_f32_16x16x32_bf16 v[20:23], v[88:91], v[40:43], v[20:23]
    v_mfma_f32_16x16x32_bf16 v[24:27], v[104:107], v[40:43], v[24:27]
    v_mfma_f32_16x16x32_bf16 v[28:31], v[120:123], v[40:43], v[28:31]
    v_mfma_f32_16x16x32_bf16 v[16:19], v[76:79], v[44:47], v[16:19]
    v_mfma_f32_16x16x32_bf16 v[20:23], v[92:95], v[44:47], v[20:23]
    v_mfma_f32_16x16x32_bf16 v[24:27], v[108:111], v[44:47], v[24:27]
    v_mfma_f32_16x16x32_bf16 v[28:31], v[124:127], v[44:47], v[28:31]
    s_nop 7
    v_max3_f32 v4, abs(v16), abs(v17), v4
    v_max3_f32 v4, abs(v18), abs(v19), v4
    v_max3_f32 v4, abs(v20), abs(v21), v4
    v_max3_f32 v4, abs(v22), abs(v23), v4
    v_max3_f32 v4, abs(v24), abs(v25), v4
    v_max3_f32 v4, abs(v26), abs(v27), v4
    v_max3_f32 v4, abs(v28), abs(v29), v4
    v_max3_f32 v4, abs(v30), abs(v31), v4
    v_fma_mixlo_f16 v24, v16, s60, 0
    v_fma_mixlo_f16 v25, v17, s60, 0
    v_fma_mixlo_f16 v26, v18, s60, 0
    v_fma_mixlo_f16 v27, v19, s60, 0
    v_fma_mixlo_f16 v28, v20, s60, 0
    v_fma_mixlo_f16 v29, v21, s60, 0
    v_fma_mixlo_f16 v30, v22, s60, 0
    v_fma_mixlo_f16 v31, v23, s60, 0
    ds_write_b128 v10, v[24:27]
    ds_write_b128 v0, v[28:31]
    ds_read_b128 v[12:15], v2
    ds_read_b128 v[16:19], v2 offset:1024
    s_waitcnt lgkmcnt(1)
    buffer_store_dwordx4 v[12:15], v3, s[44:47], s61 offen sc1
    s_waitcnt lgkmcnt(0)
    buffer_store_dwordx4 v[16:19], v3, s[44:47], s61 offen offset:1024 sc1
    s_add_u32 s61, s61, 16384
    s_nop 1
    s_cmp_lg_u32 s63, 0
    s_cbranch_scc1 K1_PDONE
    s_cmp_eq_u32 s65, 0
    s_cbranch_scc1 K1_PDONE
    s_waitcnt lgkmcnt(0)
    v_mfma_f32_16x16x32_bf16 v[16:19], v[64:67], v[48:51], 0
    v_mfma_f32_16x16x32_bf16 v[20:23], v[80:83], v[48:51], 0
    v_mfma_f32_16x16x32_bf16 v[24:27], v[96:99], v[48:51], 0
    v_mfma_f32_16x16x32_bf16 v[28:31], v[112:115], v[48:51], 0
    v_mfma_f32_16x16x32_bf16 v[16:19], v[68:71], v[52:55], v[16:19]
    v_mfma_f32_16x16x32_bf16 v[20:23], v[84:87], v[52:55], v[20:23]
    v_mfma_f32_16x16x32_bf16 v[24:27], v[100:103], v[52:55], v[24:27]
    v_mfma_f32_16x16x32_bf16 v[28:31], v[116:119], v[52:55], v[28:31]
    v_mfma_f32_16x16x32_bf16 v[16:19], v[72:75], v[56:59], v[16:19]
    v_mfma_f32_16x16x32_bf16 v[20:23], v[88:91], v[56:59], v[20:23]
    v_mfma_f32_16x16x32_bf16 v[24:27], v[104:107], v[56:59], v[24:27]
    v_mfma_f32_16x16x32_bf16 v[28:31], v[120:123], v[56:59], v[28:31]
    v_mfma_f32_16x16x32_bf16 v[16:19], v[76:79], v[60:63], v[16:19]
    v_mfma_f32_16x16x32_bf16 v[20:23], v[92:95], v[60:63], v[20:23]
    v_mfma_f32_16x16x32_bf16 v[24:27], v[108:111], v[60:63], v[24:27]
    v_mfma_f32_16x16x32_bf16 v[28:31], v[124:127], v[60:63], v[28:31]
    s_nop 7
    v_max3_f32 v4, abs(v16), abs(v17), v4
    v_max3_f32 v4, abs(v18), abs(v19), v4
    v_max3_f32 v4, abs(v20), abs(v21), v4
    v_max3_f32 v4, abs(v22), abs(v23), v4
    v_max3_f32 v4, abs(v24), abs(v25), v4
    v_max3_f32 v4, abs(v26), abs(v27), v4
    v_max3_f32 v4, abs(v28), abs(v29), v4
    v_max3_f32 v4, abs(v30), abs(v31), v4
    v_fma_mixlo_f16 v24, v16, s60, 0
    v_fma_mixlo_f16 v25, v17, s60, 0
    v_fma_mixlo_f16 v26, v18, s60, 0
    v_fma_mixlo_f16 v27, v19, s60, 0
    v_fma_mixlo_f16 v28, v20, s60, 0
    v_fma_mixlo_f16 v29, v21, s60, 0
    v_fma_mixlo_f16 v30, v22, s60, 0
    v_fma_mixlo_f16 v31, v23, s60, 0
    ds_write_b128 v10, v[24:27]
    ds_write_b128 v0, v[28:31]
    ds_read_b128 v[12:15], v2
    ds_read_b128 v[16:19], v2 offset:1024
    s_waitcnt lgkmcnt(1)
    buffer_store_dwordx4 v[12:15], v3, s[44:47], s61 offen sc1
    s_waitcnt lgkmcnt(0)
    buffer_store_dwordx4 v[16:19], v3, s[44:47], s61 offen offset:1024 sc1
K1_PDONE:
    v_cmp_le_f32 vcc, 2.0, v4
    s_cbranch_vccz K1_PSAFE
    v_mov_b32 v13, 0x10000
    s_mov_b64 exec, 1
    buffer_atomic_add v13, off, s[96:99], 0 offset:64 sc1
    s_mov_b64 exec, -1
K1_PSAFE:
K1_AU:
    v_lshrrev_b32 v4, 4, v1
    v_and_b32 v5, 15, v1
    v_xor_b32 v4, v4, v5
    v_lshlrev_b32 v4, 4, v4
    v_lshl_add_u32 v5, v5, 8, v4
    v_lshrrev_b32 v2, 4, v1
    v_and_b32 v3, 15, v1
    v_lshrrev_b32 v48, 2, v3
    v_lshl_add_u32 v48, v2, 3, v48
    v_lshlrev_b32 v48, 6, v48
    v_and_b32 v49, 3, v1
    v_lshl_add_u32 v48, v49, 3, v48
    v_and_b32 v49, 1, v2
    v_lshl_add_u32 v48, v49, 5, v48
    v_add_u32 v48, 102400, v48
    v_xor_b32 v49, 32, v48
    s_waitcnt lgkmcnt(0)
    ds_read_b64_tr_b16 v[64:65], v48 offset:0
    ds_read_b64_tr_b16 v[66:67], v48 offset:256
    ds_read_b64_tr_b16 v[80:81], v49 offset:0
    ds_read_b64_tr_b16 v[82:83], v49 offset:256
    ds_read_b64_tr_b16 v[96:97], v48 offset:8192
    ds_read_b64_tr_b16 v[98:99], v48 offset:8448
    ds_read_b64_tr_b16 v[112:113], v49 offset:8192
    ds_read_b64_tr_b16 v[114:115], v49 offset:8448
    ds_read_b64_tr_b16 v[68:69], v48 offset:2048
    ds_read_b64_tr_b16 v[70:71], v48 offset:2304
    ds_read_b64_tr_b16 v[84:85], v49 offset:2048
    ds_read_b64_tr_b16 v[86:87], v49 offset:2304
    ds_read_b64_tr_b16 v[100:101], v48 offset:10240
    ds_read_b64_tr_b16 v[102:103], v48 offset:10496
    ds_read_b64_tr_b16 v[116:117], v49 offset:10240
    ds_read_b64_tr_b16 v[118:119], v49 offset:10496
    ds_read_b64_tr_b16 v[72:73], v48 offset:4096
    ds_read_b64_tr_b16 v[74:75], v48 offset:4352
    ds_read_b64_tr_b16 v[88:89], v49 offset:4096
    ds_read_b64_tr_b16 v[90:91], v49 offset:4352
    ds_read_b64_tr_b16 v[104:105], v48 offset:12288
    ds_read_b64_tr_b16 v[106:107], v48 offset:12544
    ds_read_b64_tr_b16 v[120:121], v49 offset:12288
    ds_read_b64_tr_b16 v[122:123], v49 offset:12544
    ds_read_b64_tr_b16 v[76:77], v48 offset:6144
    ds_read_b64_tr_b16 v[78:79], v48 offset:6400
    ds_read_b64_tr_b16 v[92:93], v49 offset:6144
    ds_read_b64_tr_b16 v[94:95], v49 offset:6400
    ds_read_b64_tr_b16 v[108:109], v48 offset:14336
    ds_read_b64_tr_b16 v[110:111], v48 offset:14592
    ds_read_b64_tr_b16 v[124:125], v49 offset:14336
    ds_read_b64_tr_b16 v[126:127], v49 offset:14592
    v_and_b32 v10, 7, v3
    v_xor_b32 v10, v10, v2
    v_lshlrev_b32 v10, 4, v10
    v_lshl_add_u32 v10, v3, 7, v10
    v_add_u32 v10, 112640, v10
    s_mov_b32 s67, s22
    s_mul_i32 s27, s22, 12
    s_lshl_b32 s28, s22, 5
    s_sub_u32 s28, s28, 352
    s_cmp_lt_u32 s22, 11
    s_cselect_b32 s28, s27, s28
    s_cselect_b32 s27, 12, 32
    s_bfm_b64 s[54:55], s27, 0
    s_lshl_b32 s90, s28, 8
    s_lshl_b32 s26, s24, 2
    s_add_u32 s90, s90, s26
    s_add_u32 s48, s20, 41943040
    s_addc_u32 s49, s21, 0
    s_mov_b32 s50, 32000
    s_mov_b32 s51, 0x20000
    s_waitcnt vmcnt(0) lgkmcnt(0)
    s_barrier
    s_lshl_b32 s25, s67, 12
    v_add_u32 v6, s25, v5
    v_xor_b32 v7, 64, v6
    v_xor_b32 v8, 0x80, v6
    v_xor_b32 v9, 0xc0, v6
    ds_read_b128 v[32:35], v6
    ds_read_b128 v[36:39], v7
    ds_read_b128 v[40:43], v8
    ds_read_b128 v[44:47], v9
    s_cmp_lg_u32 s22, 15
    s_cbranch_scc1 K1_NZ
    v_lshlrev_b32 v14, 2, v1
    v_add_u32 v14, 103936, v14
    v_mov_b32 v3, 0
    ds_write_b32 v14, v3
    s_cmp_lt_u32 s2, 128
    s_cbranch_scc1 K1_NZ2
    v_mov_b32 v15, 1
    v_mov_b32 v14, 1
    s_mov_b64 exec, 1
    buffer_atomic_add v14, off, s[96:99], 0 offset:64 sc0 sc1
    s_mov_b64 exec, -1
    s_branch K1_NZ2
K1_NZ:
    s_mov_b64 exec, 1
    buffer_load_dword v2, off, s[96:99], 0 offset:192 sc1
    s_mov_b64 exec, -1
    v_lshlrev_b32 v14, 8, v1
K1_NZ2:
    v_mov_b32 v4, 0
    s_mov_b32 s95, 0
    s_sub_u32 s26, s67, s65
    s_cselect_b32 s26, 24, s26
    s_lshl_b32 s26, s26, 11
    v_add_u32 v12, s26, v10
    v_xor_b32 v13, 64, v12
    s_add_u32 s67, s67, 16
    s_min_u32 s66, s67, 24
    s_waitcnt lgkmcnt(0)
    v_mfma_f32_16x16x32_bf16 v[16:19], v[64:67], v[32:35], 0
    v_mfma_f32_16x16x32_bf16 v[20:23], v[80:83], v[32:35], 0
    v_mfma_f32_16x16x32_bf16 v[24:27], v[96:99], v[32:35], 0
    v_mfma_f32_16x16x32_bf16 v[28:31], v[112:115], v[32:35], 0
    s_lshl_b32 s25, s66, 12
    v_add_u32 v6, s25, v5
    v_xor_b32 v7, 64, v6
    v_xor_b32 v8, 0x80, v6
    v_xor_b32 v9, 0xc0, v6
    ds_read_b128 v[48:51], v6
    ds_read_b128 v[52:55], v7
    ds_read_b128 v[56:59], v8
    ds_read_b128 v[60:63], v9
    v_mfma_f32_16x16x32_bf16 v[16:19], v[68:71], v[36:39], v[16:19]
    v_mfma_f32_16x16x32_bf16 v[20:23], v[84:87], v[36:39], v[20:23]
    v_mfma_f32_16x16x32_bf16 v[24:27], v[100:103], v[36:39], v[24:27]
    v_mfma_f32_16x16x32_bf16 v[28:31], v[116:119], v[36:39], v[28:31]
    v_mfma_f32_16x16x32_bf16 v[16:19], v[72:75], v[40:43], v[16:19]
    v_mfma_f32_16x16x32_bf16 v[20:23], v[88:91], v[40:43], v[20:23]
    v_mfma_f32_16x16x32_bf16 v[24:27], v[104:107], v[40:43], v[24:27]
    v_mfma_f32_16x16x32_bf16 v[28:31], v[120:123], v[40:43], v[28:31]
    v_mfma_f32_16x16x32_bf16 v[16:19], v[76:79], v[44:47], v[16:19]
    v_mfma_f32_16x16x32_bf16 v[20:23], v[92:95], v[44:47], v[20:23]
    v_mfma_f32_16x16x32_bf16 v[24:27], v[108:111], v[44:47], v[24:27]
    v_mfma_f32_16x16x32_bf16 v[28:31], v[124:127], v[44:47], v[28:31]
    s_nop 7
    v_max3_f32 v4, abs(v16), abs(v17), v4
    v_max3_f32 v4, abs(v18), abs(v19), v4
    v_max3_f32 v4, abs(v20), abs(v21), v4
    v_max3_f32 v4, abs(v22), abs(v23), v4
    v_fma_mixlo_f16 v24, v16, 1.0, 0
    v_fma_mixlo_f16 v25, v17, 1.0, 0
    v_fma_mixlo_f16 v26, v18, 1.0, 0
    v_fma_mixlo_f16 v27, v19, 1.0, 0
    v_fma_mixlo_f16 v28, v20, 1.0, 0
    v_fma_mixlo_f16 v29, v21, 1.0, 0
    v_fma_mixlo_f16 v30, v22, 1.0, 0
    v_fma_mixlo_f16 v31, v23, 1.0, 0
    ds_write_b128 v12, v[24:27]
    ds_write_b128 v13, v[28:31]
    s_cmp_eq_u32 s22, 15
    s_cbranch_scc1 K1_END
    s_mov_b64 exec, 1
    s_waitcnt vmcnt(0)
    v_cmp_ne_u32 vcc, 0, v2
    s_cbranch_vccnz K1_ROK
    s_mov_b32 s101, 0x40000
    s_mov_b64 exec, 1
POLLR:
    buffer_load_dword v2, off, s[96:99], 0 offset:192 sc1
    s_waitcnt vmcnt(0)
    v_cmp_ne_u32 vcc, 0, v2
    s_sub_u32 s101, s101, 1
    s_cbranch_scc1 POLLDR
    s_cbranch_vccnz POLLDR
    s_sleep 4
    s_branch POLLR
POLLDR:
    s_mov_b64 exec, -1
K1_ROK:
    s_mov_b64 exec, s[54:55]
    buffer_load_dword v3, v14, s[48:51], s90 offen sc1
    s_mov_b64 exec, -1
    v_readfirstlane_b32 s95, v2
    s_cmp_ge_u32 s67, 25
    s_lshr_b32 s95, s95, 16
    s_cmp_ge_u32 s67, 25
    s_cbranch_scc1 K1_END
    s_sub_u32 s26, s67, s65
    s_cselect_b32 s26, 24, s26
    s_lshl_b32 s26, s26, 11
    v_add_u32 v12, s26, v10
    v_xor_b32 v13, 64, v12
    s_waitcnt lgkmcnt(0)
    v_mfma_f32_16x16x32_bf16 v[16:19], v[64:67], v[48:51], 0
    v_mfma_f32_16x16x32_bf16 v[20:23], v[80:83], v[48:51], 0
    v_mfma_f32_16x16x32_bf16 v[24:27], v[96:99], v[48:51], 0
    v_mfma_f32_16x16x32_bf16 v[28:31], v[112:115], v[48:51], 0
    v_mfma_f32_16x16x32_bf16 v[16:19], v[68:71], v[52:55], v[16:19]
    v_mfma_f32_16x16x32_bf16 v[20:23], v[84:87], v[52:55], v[20:23]
    v_mfma_f32_16x16x32_bf16 v[24:27], v[100:103], v[52:55], v[24:27]
    v_mfma_f32_16x16x32_bf16 v[28:31], v[116:119], v[52:55], v[28:31]
    v_mfma_f32_16x16x32_bf16 v[16:19], v[72:75], v[56:59], v[16:19]
    v_mfma_f32_16x16x32_bf16 v[20:23], v[88:91], v[56:59], v[20:23]
    v_mfma_f32_16x16x32_bf16 v[24:27], v[104:107], v[56:59], v[24:27]
    v_mfma_f32_16x16x32_bf16 v[28:31], v[120:123], v[56:59], v[28:31]
    v_mfma_f32_16x16x32_bf16 v[16:19], v[76:79], v[60:63], v[16:19]
    v_mfma_f32_16x16x32_bf16 v[20:23], v[92:95], v[60:63], v[20:23]
    v_mfma_f32_16x16x32_bf16 v[24:27], v[108:111], v[60:63], v[24:27]
    v_mfma_f32_16x16x32_bf16 v[28:31], v[124:127], v[60:63], v[28:31]
    s_nop 7
    v_max3_f32 v4, abs(v16), abs(v17), v4
    v_max3_f32 v4, abs(v18), abs(v19), v4
    v_max3_f32 v4, abs(v20), abs(v21), v4
    v_max3_f32 v4, abs(v22), abs(v23), v4
    v_fma_mixlo_f16 v24, v16, 1.0, 0
    v_fma_mixlo_f16 v25, v17, 1.0, 0
    v_fma_mixlo_f16 v26, v18, 1.0, 0
    v_fma_mixlo_f16 v27, v19, 1.0, 0
    v_fma_mixlo_f16 v28, v20, 1.0, 0
    v_fma_mixlo_f16 v29, v21, 1.0, 0
    v_fma_mixlo_f16 v30, v22, 1.0, 0
    v_fma_mixlo_f16 v31, v23, 1.0, 0
    ds_write_b128 v12, v[24:27]
    ds_write_b128 v13, v[28:31]
K1_END:
    v_cmp_le_f32 vcc, 2.0, v4
    s_cmp_lg_u64 vcc, 0
    s_cselect_b32 s95, 1, s95
    s_cmp_lg_u32 s22, 15
    s_cbranch_scc1 K1_RDONE
    s_cmp_lt_u32 s2, 128
    s_cbranch_scc1 K1_NG
    s_mov_b64 exec, 1
    s_waitcnt vmcnt(0)
    v_add_u32 v14, v14, v15
    v_and_b32 v15, 0xffff, v14
    v_cmp_eq_u32 vcc, 0x80, v15
    s_cbranch_vccz K1_NG
    buffer_store_dword v14, off, s[96:99], 0 offset:128 sc1
K1_NG:
    s_mov_b64 exec, -1
K1_RDONE:
    s_lshl_b32 s25, s22, 6
    v_add_u32 v0, s25, v1
    s_branch K2_ENTRY
K1_END2:
    s_endpgm
K2_ENTRY:
    s_mov_b32 s32, s20
    s_mov_b32 s33, s21
    s_mov_b32 s34, 42991616
    s_mov_b32 s35, 0x20000
    v_lshlrev_b32 v65, 2, v1
    v_lshlrev_b32 v66, 4, v1
    v_mov_b32 v86, 103936
    v_mov_b32 v87, 1
    v_mov_b32 v123, 0
    s_cmp_ge_u32 s22, 11
    s_cbranch_scc1 K2_LW
    v_lshrrev_b32 v72, 4, v1
    v_lshlrev_b32 v73, 2, v72
    s_mov_b32 s25, 12800
    v_and_b32 v74, 15, v1
    v_lshlrev_b32 v75, 2, v74
    v_lshlrev_b32 v74, 4, v74
    v_mad_u32_u24 v74, v72, s25, v74
    s_mov_b32 s30, 0
    s_mov_b32 s31, 0
    s_mov_b64 s[80:81], 0
    s_mul_i32 s27, s28, 12800
    s_add_u32 s27, s27, 33554432
    s_mov_b32 s25, 0x40ffff
    s_waitcnt vmcnt(0)
    v_mov_b32 v104, v3
    ds_bpermute_b32 v76, v73, v3 offset:0
    ds_bpermute_b32 v77, v73, v3 offset:16
    ds_bpermute_b32 v78, v73, v3 offset:32
    v_cmp_lt_u32 vcc, s25, v3
    s_and_b64 s[88:89], vcc, s[54:55]
    s_waitcnt lgkmcnt(0)
    v_lshrrev_b32 v79, 16, v76
    v_lshlrev_b32_sdwa v76, 2, v76 dst_sel:DWORD dst_unused:UNUSED_PAD src0_sel:DWORD src1_sel:WORD_0
    v_cmp_gt_u32 s[56:57], v79, v75
    v_add_u32 v76, v76, v74
    s_or_b64 exec, s[56:57], 1
    buffer_load_dwordx4 v[24:27], v76, s[32:35], s27 offen sc1
    s_mov_b64 exec, -1
    s_add_u32 s27, s27, 51200
    v_lshrrev_b32 v80, 16, v77
    v_lshlrev_b32_sdwa v77, 2, v77 dst_sel:DWORD dst_unused:UNUSED_PAD src0_sel:DWORD src1_sel:WORD_0
    v_cmp_gt_u32 s[64:65], v80, v75
    v_add_u32 v77, v77, v74
    s_or_b64 exec, s[64:65], 1
    buffer_load_dwordx4 v[28:31], v77, s[32:35], s27 offen sc1
    s_mov_b64 exec, -1
    s_add_u32 s27, s27, 51200
    v_lshrrev_b32 v81, 16, v78
    v_lshlrev_b32_sdwa v78, 2, v78 dst_sel:DWORD dst_unused:UNUSED_PAD src0_sel:DWORD src1_sel:WORD_0
    v_cmp_gt_u32 s[72:73], v81, v75
    v_add_u32 v78, v78, v74
    s_or_b64 exec, s[72:73], 1
    buffer_load_dwordx4 v[32:35], v78, s[32:35], s27 offen sc1
    s_mov_b64 exec, -1
    s_cmp_lg_u64 s[88:89], 0
    s_cbranch_scc1 K2_TAIL
K2_TAILR:
    v_lshlrev_b32 v72, 4, v0
    v_mov_b32 v20, 0
    v_mov_b32 v21, 0
    v_mov_b32 v22, 0
    v_mov_b32 v23, 0
    s_barrier
    s_cmp_ge_u32 s22, 6
    s_cbranch_scc1 K2_INIT_DONE
    s_cmp_eq_u32 s22, 5
    s_cbranch_scc1 K2_INIT_5
    s_lshr_b32 s25, s22, 1
    s_cmp_eq_u32 s25, 1
    s_cbranch_scc0 K2_INIT_Z
    v_mov_b32 v20, 51072
    v_mov_b32 v21, 51072
    v_mov_b32 v22, 51072
    v_mov_b32 v23, 51072
K2_INIT_Z:
    ds_write_b128 v72, v[20:23]
    s_branch K2_INIT_A
K2_INIT_5:
    v_mov_b32 v64, 111616
    ds_write_b64 v64, v[20:21]
K2_INIT_A:
    s_waitcnt lgkmcnt(0)
    s_mov_b64 exec, 1
    ds_add_u32 v86, v87 offset:20
    s_mov_b64 exec, -1
K2_INIT_DONE:
    v_mov_b32 v84, s95
    s_mov_b64 exec, 1
    ds_or_b32 v86, v84 offset:32
    s_mov_b64 exec, -1
    v_add_u32 v75, 1, v75
    v_cmp_gt_u32 s[58:59], v79, v75
    v_cmp_gt_u32 s[66:67], v80, v75
    v_cmp_gt_u32 s[74:75], v81, v75
    v_add_u32 v75, 1, v75
    v_cmp_gt_u32 s[60:61], v79, v75
    v_cmp_gt_u32 s[68:69], v80, v75
    v_cmp_gt_u32 s[76:77], v81, v75
    v_add_u32 v75, 1, v75
    v_cmp_gt_u32 s[62:63], v79, v75
    v_cmp_gt_u32 s[70:71], v80, v75
    v_cmp_gt_u32 s[78:79], v81, v75
    s_lshl_b32 s25, s28, 6
    v_add_u32 v67, s25, v65
    v_mov_b32 v68, 64
    s_mov_b32 s44, s16
    s_mov_b32 s45, s17
    s_mov_b32 s46, 66560
    s_mov_b32 s47, 0x20000
    s_mul_i32 s25, s23, 3205120
    s_add_u32 s36, s20, s25
    s_addc_u32 s37, s21, 0
    s_mov_b32 s38, 3200000
    s_mov_b32 s39, 0x20000
    s_mov_b32 s40, s18
    s_mov_b32 s41, s19
    s_mov_b32 s42, 6400000
    s_mov_b32 s43, 0x20000
    s_mov_b32 s29, 0xbfb8aa3b
    v_and_b32 v5, 7, v1
    v_lshlrev_b32 v5, 3, v5
    v_lshlrev_b32 v2, 1, v5
    v_and_b32 v3, 56, v1
    v_and_b32 v64, 2, v1
    v_lshl_add_u32 v4, v64, 1, v3
    v_and_b32 v64, 1, v1
    v_lshl_add_u32 v4, v64, 6, v4
    s_and_b32 s25, s22, 3
    s_mov_b32 s93, 0x17140b00
    s_mov_b32 s92, 0x1f1f0c0a
    s_cmp_eq_u32 s25, 1
    s_cselect_b32 s93, 0x15110701, s93
    s_cselect_b32 s92, 0x1f1f1002, s92
    s_cmp_eq_u32 s25, 2
    s_cselect_b32 s93, 0x18120906, s93
    s_cselect_b32 s92, 0x1f160f08, s92
    s_cmp_eq_u32 s25, 3
    s_cselect_b32 s93, 0x130e0503, s93
    s_cselect_b32 s92, 0x1f1f0d04, s92
    s_and_b32 s26, s22, 12
    s_lshl_b32 s26, s26, 1
    s_lshr_b32 s93, s93, s26
    s_lshr_b32 s92, s92, s26
    s_and_b32 s93, s93, 0xff
    s_and_b32 s92, s92, 0xff
    s_mul_i32 s91, s24, 100096
    s_lshl_b32 s25, s23, 6
    s_add_u32 s91, s91, s25
    s_lshl_b32 s26, s23, 6
    s_add_u32 s26, s26, 65536
    buffer_load_dwordx2 v[88:89], v5, s[44:47], s26 offen offset:0
    buffer_load_dwordx2 v[90:91], v5, s[44:47], s26 offen offset:256
    buffer_load_dwordx2 v[92:93], v5, s[44:47], s26 offen offset:512
    buffer_load_dwordx2 v[94:95], v5, s[44:47], s26 offen offset:768
K2_SBWB1:
    ds_read_b32 v85, v86 offset:20
    s_waitcnt lgkmcnt(0)
    v_cmp_gt_u32 vcc, 6, v85
    s_cbranch_vccnz K2_SBWB1
    s_cmp_eq_u32 s31, 0
    s_cbranch_scc1 K2_NOOVF
    ds_write_b32 v123, v87 offset:4864
K2_NOOVF:
    s_waitcnt vmcnt(4)
    v_and_b32 v50, 0xffff, v24
    s_mov_b64 exec, s[56:57]
    ds_add_rtn_u32 v37, v50, v68
    s_mov_b64 exec, -1
    v_and_b32 v51, 0xffff, v25
    s_mov_b64 exec, s[58:59]
    ds_add_rtn_u32 v38, v51, v68
    s_mov_b64 exec, -1
    v_and_b32 v52, 0xffff, v26
    s_mov_b64 exec, s[60:61]
    ds_add_rtn_u32 v39, v52, v68
    s_mov_b64 exec, -1
    v_and_b32 v53, 0xffff, v27
    s_mov_b64 exec, s[62:63]
    ds_add_rtn_u32 v40, v53, v68
    s_mov_b64 exec, -1
    v_and_b32 v54, 0xffff, v28
    s_mov_b64 exec, s[64:65]
    ds_add_rtn_u32 v41, v54, v68
    s_mov_b64 exec, -1
    v_and_b32 v55, 0xffff, v29
    s_mov_b64 exec, s[66:67]
    ds_add_rtn_u32 v42, v55, v68
    s_mov_b64 exec, -1
    v_and_b32 v56, 0xffff, v30
    s_mov_b64 exec, s[68:69]
    ds_add_rtn_u32 v43, v56, v68
    s_mov_b64 exec, -1
    v_and_b32 v57, 0xffff, v31
    s_mov_b64 exec, s[70:71]
    ds_add_rtn_u32 v44, v57, v68
    s_mov_b64 exec, -1
    v_and_b32 v58, 0xffff, v32
    s_mov_b64 exec, s[72:73]
    ds_add_rtn_u32 v45, v58, v68
    s_mov_b64 exec, -1
    v_and_b32 v59, 0xffff, v33
    s_mov_b64 exec, s[74:75]
    ds_add_rtn_u32 v46, v59, v68
    s_mov_b64 exec, -1
    v_and_b32 v60, 0xffff, v34
    s_mov_b64 exec, s[76:77]
    ds_add_rtn_u32 v47, v60, v68
    s_mov_b64 exec, -1
    v_and_b32 v61, 0xffff, v35
    s_mov_b64 exec, s[78:79]
    ds_add_rtn_u32 v48, v61, v68
    s_mov_b64 exec, -1
    v_and_b32 v62, 0xffff, v36
    s_mov_b64 exec, s[80:81]
    ds_add_rtn_u32 v49, v62, v68
    s_mov_b64 exec, -1
    v_mov_b32_sdwa v24, v67 dst_sel:WORD_0 dst_unused:UNUSED_PRESERVE src0_sel:DWORD
    v_add_u32 v67, 1, v67
    v_mov_b32_sdwa v25, v67 dst_sel:WORD_0 dst_unused:UNUSED_PRESERVE src0_sel:DWORD
    v_add_u32 v67, 1, v67
    v_mov_b32_sdwa v26, v67 dst_sel:WORD_0 dst_unused:UNUSED_PRESERVE src0_sel:DWORD
    v_add_u32 v67, 1, v67
    v_mov_b32_sdwa v27, v67 dst_sel:WORD_0 dst_unused:UNUSED_PRESERVE src0_sel:DWORD
    v_add_u32 v67, 253, v67
    v_mov_b32_sdwa v28, v67 dst_sel:WORD_0 dst_unused:UNUSED_PRESERVE src0_sel:DWORD
    v_add_u32 v67, 1, v67
    v_mov_b32_sdwa v29, v67 dst_sel:WORD_0 dst_unused:UNUSED_PRESERVE src0_sel:DWORD
    v_add_u32 v67, 1, v67
    v_mov_b32_sdwa v30, v67 dst_sel:WORD_0 dst_unused:UNUSED_PRESERVE src0_sel:DWORD
    v_add_u32 v67, 1, v67
    v_mov_b32_sdwa v31, v67 dst_sel:WORD_0 dst_unused:UNUSED_PRESERVE src0_sel:DWORD
    v_add_u32 v67, 253, v67
    v_mov_b32_sdwa v32, v67 dst_sel:WORD_0 dst_unused:UNUSED_PRESERVE src0_sel:DWORD
    v_add_u32 v67, 1, v67
    v_mov_b32_sdwa v33, v67 dst_sel:WORD_0 dst_unused:UNUSED_PRESERVE src0_sel:DWORD
    v_add_u32 v67, 1, v67
    v_mov_b32_sdwa v34, v67 dst_sel:WORD_0 dst_unused:UNUSED_PRESERVE src0_sel:DWORD
    v_add_u32 v67, 1, v67
    v_mov_b32_sdwa v35, v67 dst_sel:WORD_0 dst_unused:UNUSED_PRESERVE src0_sel:DWORD
    s_lshl_b32 s25, s22, 6
    s_add_u32 s25, s25, 8448
    v_add_u32 v67, s25, v1
    v_mov_b32_sdwa v36, v67 dst_sel:WORD_0 dst_unused:UNUSED_PRESERVE src0_sel:DWORD
    s_waitcnt lgkmcnt(0)
    s_mov_b64 exec, 1
    ds_add_u32 v86, v87 offset:0
    s_mov_b64 exec, -1
    s_cmp_ge_u32 s22, 7
    s_cbranch_scc1 K2_W5
    v_cmp_gt_u32 vcc, 391, v0
    v_lshlrev_b32 v72, 2, v0
    v_and_b32 v80, 7, v0
    v_lshlrev_b32 v80, 4, v80
    v_lshl_add_u32 v80, v0, 7, v80
    s_mov_b64 s[54:55], vcc
K2_SBW2:
    ds_read_b32 v85, v86 offset:0
    s_waitcnt lgkmcnt(0)
    v_cmp_gt_u32 vcc, 11, v85
    s_cbranch_vccnz K2_SBW2
    s_mov_b64 exec, s[54:55]
    ds_read_b32 v73, v72
    s_waitcnt lgkmcnt(0)
    v_lshrrev_b32 v73, 6, v73
    v_min_u32 v74, 63, v73
    v_sub_u32 v74, 63, v74
    v_lshlrev_b32 v74, 2, v74
    ds_add_rtn_u32 v75, v74, v87 offset:4096
    v_add_u32 v79, 1, v73
    v_lshrrev_b32 v79, 1, v79
    v_max_u32 v79, 1, v79
    s_waitcnt lgkmcnt(0)
    s_mov_b64 exec, 1
    ds_add_u32 v86, v87 offset:4
    s_mov_b64 exec, -1
K2_SBW3:
    ds_read_b32 v85, v86 offset:4
    s_waitcnt lgkmcnt(0)
    v_cmp_gt_u32 vcc, 7, v85
    s_cbranch_vccnz K2_SBW3
    ds_read_b32 v77, v65 offset:4096
    s_waitcnt lgkmcnt(0)
    v_mov_b32 v78, v77
    s_nop 1
    v_add_u32_dpp v78, v78, v78 row_shr:1 row_mask:0xf bank_mask:0xf bound_ctrl:0
    s_nop 1
    v_add_u32_dpp v78, v78, v78 row_shr:2 row_mask:0xf bank_mask:0xf bound_ctrl:0
    s_nop 1
    v_add_u32_dpp v78, v78, v78 row_shr:4 row_mask:0xf bank_mask:0xf bound_ctrl:0
    s_nop 1
    v_add_u32_dpp v78, v78, v78 row_shr:8 row_mask:0xf bank_mask:0xf bound_ctrl:0
    s_nop 1
    v_add_u32_dpp v78, v78, v78 row_bcast:15 row_mask:0xa bank_mask:0xf
    s_nop 1
    v_add_u32_dpp v78, v78, v78 row_bcast:31 row_mask:0xc bank_mask:0xf
    v_sub_u32 v78, v78, v77
    s_nop 0
    ds_bpermute_b32 v81, v74, v78
    s_waitcnt lgkmcnt(0)
    s_mov_b64 exec, s[54:55]
    v_add_u32 v75, v75, v81
    v_lshlrev_b32 v81, 2, v75
    ds_write_b32 v81, v80 offset:2048
    v_lshrrev_b32 v82, 4, v75
    v_lshlrev_b32 v82, 2, v82
    ds_max_u32 v82, v79 offset:4352
    v_and_b32 v81, 60, v81
    s_waitcnt lgkmcnt(0)
    s_mov_b64 exec, 1
    ds_add_u32 v86, v87 offset:8
    s_mov_b64 exec, -1
K2_SBW4:
    ds_read_b32 v85, v86 offset:8
    s_waitcnt lgkmcnt(0)
    v_cmp_gt_u32 vcc, 7, v85
    s_cbranch_vccnz K2_SBW4
    ds_read_b32 v77, v65 offset:4352
    s_waitcnt lgkmcnt(0)
    v_min_u32 v77, 0x1ff, v77
    v_lshlrev_b32 v77, 7, v77
    v_mov_b32 v78, v77
    s_nop 1
    v_add_u32_dpp v78, v78, v78 row_shr:1 row_mask:0xf bank_mask:0xf bound_ctrl:0
    s_nop 1
    v_add_u32_dpp v78, v78, v78 row_shr:2 row_mask:0xf bank_mask:0xf bound_ctrl:0
    s_nop 1
    v_add_u32_dpp v78, v78, v78 row_shr:4 row_mask:0xf bank_mask:0xf bound_ctrl:0
    s_nop 1
    v_add_u32_dpp v78, v78, v78 row_shr:8 row_mask:0xf bank_mask:0xf bound_ctrl:0
    s_nop 1
    v_add_u32_dpp v78, v78, v78 row_bcast:15 row_mask:0xa bank_mask:0xf
    s_nop 1
    v_add_u32_dpp v78, v78, v78 row_bcast:31 row_mask:0xc bank_mask:0xf
    s_nop 0
    v_readlane_b32 s25, v78, 63
    v_sub_u32 v78, v78, v77
    v_add_u32 v78, 5120, v78
    s_nop 1
    ds_bpermute_b32 v82, v82, v78
    s_cmp_le_u32 s25, 32768
    s_cbranch_scc1 K2_NC_OK
    ds_write_b32 v123, v87 offset:4864
K2_NC_OK:
    s_waitcnt lgkmcnt(0)
    s_mov_b64 exec, s[54:55]
    v_add_u32 v82, v82, v81
    ds_write_b32 v72, v82
    s_waitcnt lgkmcnt(0)
    s_mov_b64 exec, 1
    ds_add_u32 v86, v87 offset:12
    s_mov_b64 exec, -1
K2_W5:
K2_SBW5:
    ds_read_b32 v85, v86 offset:12
    s_waitcnt lgkmcnt(0)
    v_cmp_gt_u32 vcc, 8, v85
    s_cbranch_vccnz K2_SBW5
    ds_read_b32 v80, v123 offset:4864
    s_mov_b64 exec, s[56:57]
    ds_read_b32 v50, v50
    s_mov_b64 exec, s[58:59]
    ds_read_b32 v51, v51
    s_mov_b64 exec, s[60:61]
    ds_read_b32 v52, v52
    s_mov_b64 exec, s[62:63]
    ds_read_b32 v53, v53
    s_mov_b64 exec, s[64:65]
    ds_read_b32 v54, v54
    s_mov_b64 exec, s[66:67]
    ds_read_b32 v55, v55
    s_mov_b64 exec, s[68:69]
    ds_read_b32 v56, v56
    s_mov_b64 exec, s[70:71]
    ds_read_b32 v57, v57
    s_mov_b64 exec, s[72:73]
    ds_read_b32 v58, v58
    s_mov_b64 exec, s[74:75]
    ds_read_b32 v59, v59
    s_mov_b64 exec, s[76:77]
    ds_read_b32 v60, v60
    s_mov_b64 exec, s[78:79]
    ds_read_b32 v61, v61
    s_mov_b64 exec, s[80:81]
    ds_read_b32 v62, v62
    s_mov_b64 exec, -1
    s_waitcnt lgkmcnt(0)
    v_cmp_ne_u32 vcc, 0, v80
    s_cbranch_vccnz K2_NOSC
    v_add_u32 v50, v50, v37
    s_mov_b64 exec, s[56:57]
    ds_write_b32 v50, v24
    s_mov_b64 exec, -1
    v_add_u32 v51, v51, v38
    s_mov_b64 exec, s[58:59]
    ds_write_b32 v51, v25
    s_mov_b64 exec, -1
    v_add_u32 v52, v52, v39
    s_mov_b64 exec, s[60:61]
    ds_write_b32 v52, v26
    s_mov_b64 exec, -1
    v_add_u32 v53, v53, v40
    s_mov_b64 exec, s[62:63]
    ds_write_b32 v53, v27
    s_mov_b64 exec, -1
    v_add_u32 v54, v54, v41
    s_mov_b64 exec, s[64:65]
    ds_write_b32 v54, v28
    s_mov_b64 exec, -1
    v_add_u32 v55, v55, v42
    s_mov_b64 exec, s[66:67]
    ds_write_b32 v55, v29
    s_mov_b64 exec, -1
    v_add_u32 v56, v56, v43
    s_mov_b64 exec, s[68:69]
    ds_write_b32 v56, v30
    s_mov_b64 exec, -1
    v_add_u32 v57, v57, v44
    s_mov_b64 exec, s[70:71]
    ds_write_b32 v57, v31
    s_mov_b64 exec, -1
    v_add_u32 v58, v58, v45
    s_mov_b64 exec, s[72:73]
    ds_write_b32 v58, v32
    s_mov_b64 exec, -1
    v_add_u32 v59, v59, v46
    s_mov_b64 exec, s[74:75]
    ds_write_b32 v59, v33
    s_mov_b64 exec, -1
    v_add_u32 v60, v60, v47
    s_mov_b64 exec, s[76:77]
    ds_write_b32 v60, v34
    s_mov_b64 exec, -1
    v_add_u32 v61, v61, v48
    s_mov_b64 exec, s[78:79]
    ds_write_b32 v61, v35
    s_mov_b64 exec, -1
    v_add_u32 v62, v62, v49
    s_mov_b64 exec, s[80:81]
    ds_write_b32 v62, v36
    s_mov_b64 exec, -1
K2_NOSC:
    s_lshl_b32 s25, s93, 6
    v_add_u32 v72, s25, v3
    ds_read_b64 v[10:11], v72 offset:2048
    s_min_u32 s25, s92, 25
    s_lshl_b32 s25, s25, 6
    v_add_u32 v72, s25, v3
    ds_read_b64 v[12:13], v72 offset:2048
    ds_read_b32 v76, v65 offset:4352
    ds_read_b32 v80, v123 offset:4864
    s_waitcnt lgkmcnt(0)
    v_min_u32 v76, 0x1ff, v76
    v_lshlrev_b32 v77, 7, v76
    v_mov_b32 v78, v77
    s_nop 1
    v_add_u32_dpp v78, v78, v78 row_shr:1 row_mask:0xf bank_mask:0xf bound_ctrl:0
    s_nop 1
    v_add_u32_dpp v78, v78, v78 row_shr:2 row_mask:0xf bank_mask:0xf bound_ctrl:0
    s_nop 1
    v_add_u32_dpp v78, v78, v78 row_shr:4 row_mask:0xf bank_mask:0xf bound_ctrl:0
    s_nop 1
    v_add_u32_dpp v78, v78, v78 row_shr:8 row_mask:0xf bank_mask:0xf bound_ctrl:0
    s_nop 1
    v_add_u32_dpp v78, v78, v78 row_bcast:15 row_mask:0xa bank_mask:0xf
    s_nop 1
    v_add_u32_dpp v78, v78, v78 row_bcast:31 row_mask:0xc bank_mask:0xf
    v_readfirstlane_b32 s31, v80
    v_sub_u32 v78, v78, v77
    v_add_u32 v78, 5120, v78
    s_nop 0
    v_readlane_b32 s48, v78, s93
    v_readlane_b32 s52, v76, s93
    v_readlane_b32 s50, v78, s92
    v_readlane_b32 s53, v76, s92
    s_nop 3
    s_sub_u32 s52, s52, 1
    s_mov_b32 s49, s52
    s_sub_u32 s51, s53, 1
    s_cmp_eq_u32 s53, 0
    s_cselect_b32 s50, 37888, s50
    s_cselect_b32 s51, 100, s51
    s_lshl_b32 s27, s22, 9
    s_add_u32 s27, s27, 105984
    v_lshl_add_u32 v63, v1, 3, s27
    ds_write_b64 v63, v[70:71]
    s_branch K2_FINB
K2_LW:
    v_lshrrev_b32 v76, 5, v1
    v_lshlrev_b32 v77, 2, v76
    v_and_b32 v78, 31, v1
    v_lshlrev_b32 v79, 1, v78
    v_lshlrev_b32 v78, 4, v78
    s_mov_b32 s25, 25600
    v_mad_u32_u24 v78, v76, s25, v78
    s_lshl_b32 s25, s28, 9
    v_add_u32 v80, s25, v66
    s_waitcnt vmcnt(0)
    v_mov_b32 v104, v3
    s_mov_b32 s44, s16
    s_mov_b32 s45, s17
    s_mov_b32 s46, 66560
    s_mov_b32 s47, 0x20000
    s_mul_i32 s25, s23, 3205120
    s_add_u32 s36, s20, s25
    s_addc_u32 s37, s21, 0
    s_mov_b32 s38, 3200000
    s_mov_b32 s39, 0x20000
    s_mov_b32 s40, s18
    s_mov_b32 s41, s19
    s_mov_b32 s42, 6400000
    s_mov_b32 s43, 0x20000
    s_mov_b32 s29, 0xbfb8aa3b
    v_and_b32 v5, 7, v1
    v_lshlrev_b32 v5, 3, v5
    v_lshlrev_b32 v2, 1, v5
    v_and_b32 v3, 56, v1
    v_and_b32 v64, 2, v1
    v_lshl_add_u32 v4, v64, 1, v3
    v_and_b32 v64, 1, v1
    v_lshl_add_u32 v4, v64, 6, v4
    s_and_b32 s25, s22, 3
    s_mov_b32 s93, 0x17140b00
    s_mov_b32 s92, 0x1f1f0c0a
    s_cmp_eq_u32 s25, 1
    s_cselect_b32 s93, 0x15110701, s93
    s_cselect_b32 s92, 0x1f1f1002, s92
    s_cmp_eq_u32 s25, 2
    s_cselect_b32 s93, 0x18120906, s93
    s_cselect_b32 s92, 0x1f160f08, s92
    s_cmp_eq_u32 s25, 3
    s_cselect_b32 s93, 0x130e0503, s93
    s_cselect_b32 s92, 0x1f1f0d04, s92
    s_and_b32 s26, s22, 12
    s_lshl_b32 s26, s26, 1
    s_lshr_b32 s93, s93, s26
    s_lshr_b32 s92, s92, s26
    s_and_b32 s93, s93, 0xff
    s_and_b32 s92, s92, 0xff
    s_mul_i32 s91, s24, 100096
    s_lshl_b32 s25, s23, 6
    s_add_u32 s91, s91, s25
    s_lshl_b32 s26, s23, 6
    s_add_u32 s26, s26, 65536
    buffer_load_dwordx2 v[88:89], v5, s[44:47], s26 offen offset:0
    buffer_load_dwordx2 v[90:91], v5, s[44:47], s26 offen offset:256
    buffer_load_dwordx2 v[92:93], v5, s[44:47], s26 offen offset:512
    buffer_load_dwordx2 v[94:95], v5, s[44:47], s26 offen offset:768
    s_mul_i32 s27, s28, 25600
    s_add_u32 s27, s27, 35651584
    s_cmp_eq_u32 s22, 15
    s_cbranch_scc1 K2_SW
    ds_bpermute_b32 v105, v77, v104 offset:0
    ds_bpermute_b32 v106, v77, v104 offset:8
    ds_bpermute_b32 v107, v77, v104 offset:16
    ds_bpermute_b32 v108, v77, v104 offset:24
    ds_bpermute_b32 v109, v77, v104 offset:32
    ds_bpermute_b32 v110, v77, v104 offset:40
    ds_bpermute_b32 v111, v77, v104 offset:48
    ds_bpermute_b32 v112, v77, v104 offset:56
    s_waitcnt lgkmcnt(0)
    s_barrier
    s_lshl_b32 s25, s28, 9
    s_add_u32 s25, s25, 38400
    v_lshrrev_b32 v81, 16, v105
    v_lshlrev_b32_sdwa v82, 3, v105 dst_sel:DWORD dst_unused:UNUSED_PAD src0_sel:DWORD src1_sel:WORD_0
    v_cmp_gt_u32 vcc, v81, v79
    v_add_u32 v82, v82, v78
    ds_bpermute_b32 v105, v77, v104 offset:64
    s_or_b64 exec, vcc, 1
    buffer_load_dwordx4 v[16:19], v82, s[32:35], s27 offen sc1
    s_mov_b64 exec, -1
    s_add_u32 s27, s27, 51200
    v_lshrrev_b32 v81, 16, v106
    v_lshlrev_b32_sdwa v82, 3, v106 dst_sel:DWORD dst_unused:UNUSED_PAD src0_sel:DWORD src1_sel:WORD_0
    v_cmp_gt_u32 vcc, v81, v79
    v_add_u32 v82, v82, v78
    ds_bpermute_b32 v106, v77, v104 offset:72
    s_or_b64 exec, vcc, 1
    buffer_load_dwordx4 v[20:23], v82, s[32:35], s27 offen sc1
    s_mov_b64 exec, -1
    s_add_u32 s27, s27, 51200
    v_lshrrev_b32 v81, 16, v107
    v_lshlrev_b32_sdwa v82, 3, v107 dst_sel:DWORD dst_unused:UNUSED_PAD src0_sel:DWORD src1_sel:WORD_0
    v_cmp_gt_u32 vcc, v81, v79
    v_add_u32 v82, v82, v78
    ds_bpermute_b32 v107, v77, v104 offset:80
    s_or_b64 exec, vcc, 1
    buffer_load_dwordx4 v[24:27], v82, s[32:35], s27 offen sc1
    s_mov_b64 exec, -1
    s_add_u32 s27, s27, 51200
    v_lshrrev_b32 v81, 16, v108
    v_lshlrev_b32_sdwa v82, 3, v108 dst_sel:DWORD dst_unused:UNUSED_PAD src0_sel:DWORD src1_sel:WORD_0
    v_cmp_gt_u32 vcc, v81, v79
    v_add_u32 v82, v82, v78
    ds_bpermute_b32 v108, v77, v104 offset:88
    s_or_b64 exec, vcc, 1
    buffer_load_dwordx4 v[28:31], v82, s[32:35], s27 offen sc1
    s_mov_b64 exec, -1
    s_add_u32 s27, s27, 51200
    v_lshrrev_b32 v81, 16, v109
    v_lshlrev_b32_sdwa v82, 3, v109 dst_sel:DWORD dst_unused:UNUSED_PAD src0_sel:DWORD src1_sel:WORD_0
    v_cmp_gt_u32 vcc, v81, v79
    v_add_u32 v82, v82, v78
    ds_bpermute_b32 v109, v77, v104 offset:96
    s_or_b64 exec, vcc, 1
    buffer_load_dwordx4 v[32:35], v82, s[32:35], s27 offen sc1
    s_mov_b64 exec, -1
    s_add_u32 s27, s27, 51200
    v_lshrrev_b32 v81, 16, v110
    v_lshlrev_b32_sdwa v82, 3, v110 dst_sel:DWORD dst_unused:UNUSED_PAD src0_sel:DWORD src1_sel:WORD_0
    v_cmp_gt_u32 vcc, v81, v79
    v_add_u32 v82, v82, v78
    ds_bpermute_b32 v110, v77, v104 offset:104
    s_or_b64 exec, vcc, 1
    buffer_load_dwordx4 v[36:39], v82, s[32:35], s27 offen sc1
    s_mov_b64 exec, -1
    s_add_u32 s27, s27, 51200
    v_lshrrev_b32 v81, 16, v111
    v_lshlrev_b32_sdwa v82, 3, v111 dst_sel:DWORD dst_unused:UNUSED_PAD src0_sel:DWORD src1_sel:WORD_0
    v_cmp_gt_u32 vcc, v81, v79
    v_add_u32 v82, v82, v78
    ds_bpermute_b32 v111, v77, v104 offset:112
    s_or_b64 exec, vcc, 1
    buffer_load_dwordx4 v[40:43], v82, s[32:35], s27 offen sc1
    s_mov_b64 exec, -1
    s_add_u32 s27, s27, 51200
    v_lshrrev_b32 v81, 16, v112
    v_lshlrev_b32_sdwa v82, 3, v112 dst_sel:DWORD dst_unused:UNUSED_PAD src0_sel:DWORD src1_sel:WORD_0
    v_cmp_gt_u32 vcc, v81, v79
    v_add_u32 v82, v82, v78
    ds_bpermute_b32 v112, v77, v104 offset:120
    s_or_b64 exec, vcc, 1
    buffer_load_dwordx4 v[44:47], v82, s[32:35], s27 offen sc1
    s_mov_b64 exec, -1
    s_add_u32 s27, s27, 51200
    s_waitcnt lgkmcnt(0)
    v_lshrrev_b32 v81, 16, v105
    v_lshlrev_b32_sdwa v82, 3, v105 dst_sel:DWORD dst_unused:UNUSED_PAD src0_sel:DWORD src1_sel:WORD_0
    v_cmp_gt_u32 vcc, v81, v79
    v_add_u32 v82, v82, v78
    s_or_b64 exec, vcc, 1
    buffer_load_dwordx4 v[48:51], v82, s[32:35], s27 offen sc1
    s_mov_b64 exec, -1
    s_add_u32 s27, s27, 51200
    v_lshrrev_b32 v81, 16, v106
    v_lshlrev_b32_sdwa v82, 3, v106 dst_sel:DWORD dst_unused:UNUSED_PAD src0_sel:DWORD src1_sel:WORD_0
    v_cmp_gt_u32 vcc, v81, v79
    v_add_u32 v82, v82, v78
    s_or_b64 exec, vcc, 1
    buffer_load_dwordx4 v[52:55], v82, s[32:35], s27 offen sc1
    s_mov_b64 exec, -1
    s_add_u32 s27, s27, 51200
    v_lshrrev_b32 v81, 16, v107
    v_lshlrev_b32_sdwa v82, 3, v107 dst_sel:DWORD dst_unused:UNUSED_PAD src0_sel:DWORD src1_sel:WORD_0
    v_cmp_gt_u32 vcc, v81, v79
    v_add_u32 v82, v82, v78
    s_or_b64 exec, vcc, 1
    buffer_load_dwordx4 v[56:59], v82, s[32:35], s27 offen sc1
    s_mov_b64 exec, -1
    s_add_u32 s27, s27, 51200
    v_lshrrev_b32 v81, 16, v108
    v_lshlrev_b32_sdwa v82, 3, v108 dst_sel:DWORD dst_unused:UNUSED_PAD src0_sel:DWORD src1_sel:WORD_0
    v_cmp_gt_u32 vcc, v81, v79
    v_add_u32 v82, v82, v78
    s_or_b64 exec, vcc, 1
    buffer_load_dwordx4 v[60:63], v82, s[32:35], s27 offen sc1
    s_mov_b64 exec, -1
    s_add_u32 s27, s27, 51200
    v_lshrrev_b32 v81, 16, v109
    v_lshlrev_b32_sdwa v82, 3, v109 dst_sel:DWORD dst_unused:UNUSED_PAD src0_sel:DWORD src1_sel:WORD_0
    v_cmp_gt_u32 vcc, v81, v79
    v_add_u32 v82, v82, v78
    s_or_b64 exec, vcc, 1
    buffer_load_dwordx4 v[96:99], v82, s[32:35], s27 offen sc1
    s_mov_b64 exec, -1
    s_add_u32 s27, s27, 51200
    v_lshrrev_b32 v81, 16, v110
    v_lshlrev_b32_sdwa v82, 3, v110 dst_sel:DWORD dst_unused:UNUSED_PAD src0_sel:DWORD src1_sel:WORD_0
    v_cmp_gt_u32 vcc, v81, v79
    v_add_u32 v82, v82, v78
    s_or_b64 exec, vcc, 1
    buffer_load_dwordx4 v[100:103], v82, s[32:35], s27 offen sc1
    s_mov_b64 exec, -1
    s_add_u32 s27, s27, 51200
    v_lshrrev_b32 v81, 16, v111
    v_lshlrev_b32_sdwa v82, 3, v111 dst_sel:DWORD dst_unused:UNUSED_PAD src0_sel:DWORD src1_sel:WORD_0
    v_cmp_gt_u32 vcc, v81, v79
    v_add_u32 v82, v82, v78
    s_or_b64 exec, vcc, 1
    buffer_load_dwordx4 v[6:9], v82, s[32:35], s27 offen sc1
    s_mov_b64 exec, -1
    s_add_u32 s27, s27, 51200
    v_lshrrev_b32 v81, 16, v112
    v_lshlrev_b32_sdwa v82, 3, v112 dst_sel:DWORD dst_unused:UNUSED_PAD src0_sel:DWORD src1_sel:WORD_0
    v_cmp_gt_u32 vcc, v81, v79
    v_add_u32 v82, v82, v78
    s_or_b64 exec, vcc, 1
    buffer_load_dwordx4 v[10:13], v82, s[32:35], s27 offen sc1
    s_mov_b64 exec, -1
    v_mov_b32 v84, s95
    s_mov_b64 exec, 1
    ds_or_b32 v86, v84 offset:32
    s_mov_b64 exec, -1
    s_waitcnt vmcnt(15)
    ds_write_b128 v80, v[16:19] offset:38400
    s_waitcnt vmcnt(14)
    ds_write_b128 v80, v[20:23] offset:39424
    s_waitcnt vmcnt(13)
    ds_write_b128 v80, v[24:27] offset:40448
    s_waitcnt vmcnt(12)
    ds_write_b128 v80, v[28:31] offset:41472
    s_waitcnt vmcnt(11)
    ds_write_b128 v80, v[32:35] offset:42496
    s_waitcnt vmcnt(10)
    ds_write_b128 v80, v[36:39] offset:43520
    s_waitcnt vmcnt(9)
    ds_write_b128 v80, v[40:43] offset:44544
    s_waitcnt vmcnt(8)
    ds_write_b128 v80, v[44:47] offset:45568
    s_waitcnt vmcnt(7)
    ds_write_b128 v80, v[48:51] offset:46592
    s_waitcnt vmcnt(6)
    ds_write_b128 v80, v[52:55] offset:47616
    s_waitcnt vmcnt(5)
    ds_write_b128 v80, v[56:59] offset:48640
    s_waitcnt vmcnt(4)
    ds_write_b128 v80, v[60:63] offset:49664
    s_waitcnt vmcnt(3)
    ds_write_b128 v80, v[96:99] offset:50688
    s_waitcnt vmcnt(2)
    ds_write_b128 v80, v[100:103] offset:51712
    s_waitcnt vmcnt(1)
    ds_write_b128 v80, v[6:9] offset:52736
    s_waitcnt vmcnt(0)
    ds_write_b128 v80, v[10:13] offset:53760
    s_branch K2_FINB
K2_SW:
    s_waitcnt lgkmcnt(0)
    v_mov_b32 v16, 0xffff23c0
    v_mov_b32 v17, 0xffff23c0
    v_mov_b32 v18, 0xffff23c0
    v_mov_b32 v19, 0xffff23c0
    s_barrier
    ds_write_b128 v66, v[16:19] offset:5120
    ds_write_b128 v66, v[16:19] offset:6144
    ds_write_b128 v66, v[16:19] offset:7168
    ds_write_b128 v66, v[16:19] offset:8192
    ds_write_b128 v66, v[16:19] offset:9216
    ds_write_b128 v66, v[16:19] offset:10240
    ds_write_b128 v66, v[16:19] offset:11264
    ds_write_b128 v66, v[16:19] offset:12288
    ds_write_b128 v66, v[16:19] offset:13312
    ds_write_b128 v66, v[16:19] offset:14336
    ds_write_b128 v66, v[16:19] offset:15360
    ds_write_b128 v66, v[16:19] offset:16384
    ds_write_b128 v66, v[16:19] offset:17408
    ds_write_b128 v66, v[16:19] offset:18432
    ds_write_b128 v66, v[16:19] offset:19456
    ds_write_b128 v66, v[16:19] offset:20480
    ds_write_b128 v66, v[16:19] offset:21504
    ds_write_b128 v66, v[16:19] offset:22528
    ds_write_b128 v66, v[16:19] offset:23552
    ds_write_b128 v66, v[16:19] offset:24576
    ds_write_b128 v66, v[16:19] offset:25600
    ds_write_b128 v66, v[16:19] offset:26624
    ds_write_b128 v66, v[16:19] offset:27648
    ds_write_b128 v66, v[16:19] offset:28672
    ds_write_b128 v66, v[16:19] offset:29696
    ds_write_b128 v66, v[16:19] offset:30720
    ds_write_b128 v66, v[16:19] offset:31744
    ds_write_b128 v66, v[16:19] offset:32768
    ds_write_b128 v66, v[16:19] offset:33792
    ds_write_b128 v66, v[16:19] offset:34816
    ds_write_b128 v66, v[16:19] offset:35840
    ds_write_b128 v66, v[16:19] offset:36864
    s_bfm_b64 exec, 32, 0
    ds_write_b128 v66, v[16:19] offset:37888
    s_waitcnt lgkmcnt(0)
    s_mov_b64 exec, 1
    ds_add_u32 v86, v87 offset:12
    s_mov_b64 exec, -1
    s_mov_b32 s101, 0x40000
    s_mov_b64 exec, 1
POLLG:
    buffer_load_dword v53, off, s[96:99], 0 offset:128 sc1
    s_waitcnt vmcnt(0)
    v_cmp_ne_u32 vcc, 0, v53
    s_sub_u32 s101, s101, 1
    s_cbranch_scc1 POLLDG
    s_cbranch_vccnz POLLDG
    s_sleep 4
    s_branch POLLG
POLLDG:
    s_mov_b64 exec, -1
    v_readfirstlane_b32 s25, v53
    s_nop 3
    s_lshr_b32 s25, s25, 16
    s_or_b32 s95, s95, s25
    v_mov_b32 v84, s95
    s_mov_b64 exec, 1
    ds_or_b32 v86, v84 offset:32
    s_mov_b64 exec, -1
K2_FINB:
    s_mov_b64 exec, -1
    s_waitcnt vmcnt(0)
K2_FINC:
    v_or3_b32 v72, v88, v89, v90
    v_or3_b32 v73, v91, v92, v93
    v_or3_b32 v72, v94, v95, v72
    v_or_b32 v72, v72, v73
    v_and_b32 v72, 0x40004000, v72
    v_cmp_ne_u32 vcc, 0, v72
    s_cbranch_vccz K2_WOK
    ds_or_b32 v86, v87 offset:32
K2_WOK:
    s_mov_b32 s25, 0x05040100
    s_mov_b32 s26, 0x07060302
    v_perm_b32 v112, v90, v88, s25
    v_perm_b32 v113, v94, v92, s25
    v_perm_b32 v114, v90, v88, s26
    v_perm_b32 v115, v94, v92, s26
    v_perm_b32 v116, v91, v89, s25
    v_perm_b32 v117, v95, v93, s25
    v_perm_b32 v118, v91, v89, s26
    v_perm_b32 v119, v95, v93, s26
    s_waitcnt lgkmcnt(0)
    s_barrier
    s_cmp_lt_u32 s22, 11
    s_cbranch_scc1 K2_HAVEBI
    s_lshl_b32 s25, s93, 6
    v_add_u32 v72, s25, v3
    ds_read_b64 v[10:11], v72 offset:2048
    s_min_u32 s25, s92, 25
    s_lshl_b32 s25, s25, 6
    v_add_u32 v72, s25, v3
    ds_read_b64 v[12:13], v72 offset:2048
    ds_read_b32 v76, v65 offset:4352
    ds_read_b32 v80, v123 offset:4864
    s_waitcnt lgkmcnt(0)
    v_min_u32 v76, 0x1ff, v76
    v_lshlrev_b32 v77, 7, v76
    v_mov_b32 v78, v77
    s_nop 1
    v_add_u32_dpp v78, v78, v78 row_shr:1 row_mask:0xf bank_mask:0xf bound_ctrl:0
    s_nop 1
    v_add_u32_dpp v78, v78, v78 row_shr:2 row_mask:0xf bank_mask:0xf bound_ctrl:0
    s_nop 1
    v_add_u32_dpp v78, v78, v78 row_shr:4 row_mask:0xf bank_mask:0xf bound_ctrl:0
    s_nop 1
    v_add_u32_dpp v78, v78, v78 row_shr:8 row_mask:0xf bank_mask:0xf bound_ctrl:0
    s_nop 1
    v_add_u32_dpp v78, v78, v78 row_bcast:15 row_mask:0xa bank_mask:0xf
    s_nop 1
    v_add_u32_dpp v78, v78, v78 row_bcast:31 row_mask:0xc bank_mask:0xf
    v_readfirstlane_b32 s31, v80
    v_sub_u32 v78, v78, v77
    v_add_u32 v78, 5120, v78
    s_nop 0
    v_readlane_b32 s48, v78, s93
    v_readlane_b32 s52, v76, s93
    v_readlane_b32 s50, v78, s92
    v_readlane_b32 s53, v76, s92
    s_nop 3
    s_sub_u32 s52, s52, 1
    s_mov_b32 s49, s52
    s_sub_u32 s51, s53, 1
    s_cmp_eq_u32 s53, 0
    s_cselect_b32 s50, 37888, s50
    s_cselect_b32 s51, 100, s51
K2_HAVEBI:
    s_cmp_lg_u32 s31, 0
    s_cbranch_scc1 K2_FALLBACK
    s_mov_b32 s56, 0xbfb8aa3b
    s_mov_b32 s57, 0xbfb8aa3b
    ds_read_b32 v42, v86 offset:32
    v_xor_b32 v9, v10, v2
    v_xor_b32 v106, v11, v2
    v_add_u32 v9, 112640, v9
    v_add_u32 v106, 112640, v106
    ds_read_b128 v[16:19], v9
    ds_read_b128 v[20:23], v106
    v_add_u32 v9, s48, v4
    ds_read_b32 v40, v9
    s_add_u32 s48, s48, 128
    s_sub_u32 s49, s49, 1
    s_cbranch_scc1 K2_SWF0
K2_SWRF0:
    v_add_u32 v9, s48, v4
    ds_read_b32 v6, v9
    s_waitcnt lgkmcnt(1)
    v_lshlrev_b32_sdwa v7, 7, v40 dst_sel:DWORD dst_unused:UNUSED_PAD src0_sel:DWORD src1_sel:WORD_1
    v_lshlrev_b32_sdwa v8, 3, v40 dst_sel:DWORD dst_unused:UNUSED_PAD src0_sel:DWORD src1_sel:WORD_0
    s_nop 0
    ds_read_b64 v[14:15], v8 offset:38400
    v_add_u32_dpp v104, v7, v2 quad_perm:[0,0,0,0] row_mask:0xf bank_mask:0xf
    v_add_u32_dpp v105, v7, v2 quad_perm:[1,1,1,1] row_mask:0xf bank_mask:0xf
    v_add_u32_dpp v106, v7, v2 quad_perm:[2,2,2,2] row_mask:0xf bank_mask:0xf
    v_add_u32_dpp v107, v7, v2 quad_perm:[3,3,3,3] row_mask:0xf bank_mask:0xf
    buffer_load_dwordx4 v[56:59], v104, s[36:39], 0 offen sc1
    buffer_load_dwordx4 v[60:63], v105, s[36:39], 0 offen sc1
    buffer_load_dwordx4 v[64:67], v106, s[36:39], 0 offen sc1
    buffer_load_dwordx4 v[68:71], v107, s[36:39], 0 offen sc1
    v_cvt_f32_f16 v24, v16
    v_cvt_f32_f16 v26, v20
    v_cvt_f32_f16 v28, v17
    v_cvt_f32_f16 v30, v21
    v_cvt_f32_f16 v32, v18
    v_cvt_f32_f16 v34, v22
    v_cvt_f32_f16 v36, v19
    v_cvt_f32_f16 v38, v23
    v_mov_b32 v25, v24
    v_mov_b32 v27, v26
    v_mov_b32 v29, v28
    v_mov_b32 v31, v30
    v_mov_b32 v33, v32
    v_mov_b32 v35, v34
    v_mov_b32 v37, v36
    v_mov_b32 v39, v38
    v_cmp_ne_u32 vcc, 0, v42
    s_cbranch_vccnz K2_LOOPS
K2_QX:
    s_waitcnt lgkmcnt(0)
    v_mfma_f32_4x4x4_16b_bf16 v[40:43], v[14:15], v[112:113], v[24:27]
    v_mfma_f32_4x4x4_16b_bf16 v[44:47], v[14:15], v[114:115], v[28:31]
    v_mfma_f32_4x4x4_16b_bf16 v[48:51], v[14:15], v[116:117], v[32:35]
    v_mfma_f32_4x4x4_16b_bf16 v[52:55], v[14:15], v[118:119], v[36:39]
    v_lshlrev_b32_sdwa v7, 7, v6 dst_sel:DWORD dst_unused:UNUSED_PAD src0_sel:DWORD src1_sel:WORD_1
    v_lshlrev_b32_sdwa v8, 3, v6 dst_sel:DWORD dst_unused:UNUSED_PAD src0_sel:DWORD src1_sel:WORD_0
    s_add_u32 s48, s48, 128
    s_sub_u32 s49, s49, 1
    s_cbranch_scc1 K2_SWK2_QX0
K2_SWRK2_QX0:
    ds_read_b64 v[14:15], v8 offset:38400
    v_add_u32_dpp v104, v7, v2 quad_perm:[0,0,0,0] row_mask:0xf bank_mask:0xf
    v_add_u32_dpp v105, v7, v2 quad_perm:[1,1,1,1] row_mask:0xf bank_mask:0xf
    v_add_u32_dpp v106, v7, v2 quad_perm:[2,2,2,2] row_mask:0xf bank_mask:0xf
    v_add_u32_dpp v107, v7, v2 quad_perm:[3,3,3,3] row_mask:0xf bank_mask:0xf
    buffer_load_dwordx4 v[72:75], v104, s[36:39], 0 offen sc1
    buffer_load_dwordx4 v[76:79], v105, s[36:39], 0 offen sc1
    buffer_load_dwordx4 v[80:83], v106, s[36:39], 0 offen sc1
    buffer_load_dwordx4 v[84:87], v107, s[36:39], 0 offen sc1
    v_add_u32 v9, s48, v4
    ds_read_b32 v6, v9
    s_waitcnt vmcnt(4)
    v_fma_mix_f32 v40, v40, s29, v56 op_sel_hi:[0,0,1]
    v_fma_mix_f32 v44, v44, s29, v57 op_sel_hi:[0,0,1]
    v_fma_mix_f32 v48, v48, s29, v58 op_sel_hi:[0,0,1]
    v_fma_mix_f32 v52, v52, s29, v59 op_sel_hi:[0,0,1]
    v_fma_mix_f32 v41, v41, s29, v60 op_sel_hi:[0,0,1]
    v_fma_mix_f32 v45, v45, s29, v61 op_sel_hi:[0,0,1]
    v_fma_mix_f32 v49, v49, s29, v62 op_sel_hi:[0,0,1]
    v_fma_mix_f32 v53, v53, s29, v63 op_sel_hi:[0,0,1]
    v_fma_mix_f32 v42, v42, s29, v64 op_sel_hi:[0,0,1]
    v_fma_mix_f32 v46, v46, s29, v65 op_sel_hi:[0,0,1]
    v_fma_mix_f32 v50, v50, s29, v66 op_sel_hi:[0,0,1]
    v_fma_mix_f32 v54, v54, s29, v67 op_sel_hi:[0,0,1]
    v_fma_mix_f32 v43, v43, s29, v68 op_sel_hi:[0,0,1]
    v_fma_mix_f32 v47, v47, s29, v69 op_sel_hi:[0,0,1]
    v_fma_mix_f32 v51, v51, s29, v70 op_sel_hi:[0,0,1]
    v_fma_mix_f32 v55, v55, s29, v71 op_sel_hi:[0,0,1]
    v_exp_f32 v104, v40
    v_exp_f32 v105, v44
    v_exp_f32 v106, v48
    v_exp_f32 v107, v52
    v_exp_f32 v108, v41
    v_exp_f32 v109, v45
    v_exp_f32 v110, v49
    v_exp_f32 v111, v53
    v_pk_add_f32 v[104:105], v[104:105], 1.0 op_sel_hi:[1,0]
    v_pk_add_f32 v[106:107], v[106:107], 1.0 op_sel_hi:[1,0]
    v_pk_fma_f32 v[88:89], v[60:61], v[104:105], v[56:57]
    v_pk_fma_f32 v[90:91], v[62:63], v[106:107], v[58:59]
    v_pk_fma_f32 v[92:93], v[104:105], v[108:109], v[104:105]
    v_pk_fma_f32 v[94:95], v[106:107], v[110:111], v[106:107]
    v_pk_fma_f32 v[88:89], v[56:57], v[108:109], v[88:89]
    v_pk_fma_f32 v[90:91], v[58:59], v[110:111], v[90:91]
    v_exp_f32 v104, v42
    v_exp_f32 v105, v46
    v_exp_f32 v106, v50
    v_exp_f32 v107, v54
    v_exp_f32 v108, v43
    v_exp_f32 v109, v47
    v_exp_f32 v110, v51
    v_exp_f32 v111, v55
    v_pk_add_f32 v[104:105], v[104:105], 1.0 op_sel_hi:[1,0]
    v_pk_add_f32 v[106:107], v[106:107], 1.0 op_sel_hi:[1,0]
    v_pk_fma_f32 v[96:97], v[68:69], v[104:105], v[64:65]
    v_pk_fma_f32 v[98:99], v[70:71], v[106:107], v[66:67]
    v_pk_fma_f32 v[100:101], v[104:105], v[108:109], v[104:105]
    v_pk_fma_f32 v[102:103], v[106:107], v[110:111], v[106:107]
    v_pk_fma_f32 v[96:97], v[64:65], v[108:109], v[96:97]
    v_pk_fma_f32 v[98:99], v[66:67], v[110:111], v[98:99]
    s_sub_u32 s52, s52, 1
    s_cbranch_scc0 K2_QX_C
    s_call_b64 s[82:83], K2_EPIQ
    s_branch K2_QY
K2_QX_C:
    s_waitcnt lgkmcnt(0)
    v_mfma_f32_4x4x4_16b_bf16 v[40:43], v[14:15], v[112:113], v[24:27]
    v_mfma_f32_4x4x4_16b_bf16 v[44:47], v[14:15], v[114:115], v[28:31]
    v_mfma_f32_4x4x4_16b_bf16 v[48:51], v[14:15], v[116:117], v[32:35]
    v_mfma_f32_4x4x4_16b_bf16 v[52:55], v[14:15], v[118:119], v[36:39]
    v_lshlrev_b32_sdwa v7, 7, v6 dst_sel:DWORD dst_unused:UNUSED_PAD src0_sel:DWORD src1_sel:WORD_1
    v_lshlrev_b32_sdwa v8, 3, v6 dst_sel:DWORD dst_unused:UNUSED_PAD src0_sel:DWORD src1_sel:WORD_0
    s_add_u32 s48, s48, 128
    s_sub_u32 s49, s49, 1
    s_cbranch_scc1 K2_SWK2_QX1
K2_SWRK2_QX1:
    ds_read_b64 v[14:15], v8 offset:38400
    v_add_u32_dpp v104, v7, v2 quad_perm:[0,0,0,0] row_mask:0xf bank_mask:0xf
    v_add_u32_dpp v105, v7, v2 quad_perm:[1,1,1,1] row_mask:0xf bank_mask:0xf
    v_add_u32_dpp v106, v7, v2 quad_perm:[2,2,2,2] row_mask:0xf bank_mask:0xf
    v_add_u32_dpp v107, v7, v2 quad_perm:[3,3,3,3] row_mask:0xf bank_mask:0xf
    buffer_load_dwordx4 v[56:59], v104, s[36:39], 0 offen sc1
    buffer_load_dwordx4 v[60:63], v105, s[36:39], 0 offen sc1
    buffer_load_dwordx4 v[64:67], v106, s[36:39], 0 offen sc1
    buffer_load_dwordx4 v[68:71], v107, s[36:39], 0 offen sc1
    v_add_u32 v9, s48, v4
    ds_read_b32 v6, v9
    s_waitcnt vmcnt(4)
    v_fma_mix_f32 v40, v40, s29, v72 op_sel_hi:[0,0,1]
    v_fma_mix_f32 v44, v44, s29, v73 op_sel_hi:[0,0,1]
    v_fma_mix_f32 v48, v48, s29, v74 op_sel_hi:[0,0,1]
    v_fma_mix_f32 v52, v52, s29, v75 op_sel_hi:[0,0,1]
    v_fma_mix_f32 v41, v41, s29, v76 op_sel_hi:[0,0,1]
    v_fma_mix_f32 v45, v45, s29, v77 op_sel_hi:[0,0,1]
    v_fma_mix_f32 v49, v49, s29, v78 op_sel_hi:[0,0,1]
    v_fma_mix_f32 v53, v53, s29, v79 op_sel_hi:[0,0,1]
    v_fma_mix_f32 v42, v42, s29, v80 op_sel_hi:[0,0,1]
    v_fma_mix_f32 v46, v46, s29, v81 op_sel_hi:[0,0,1]
    v_fma_mix_f32 v50, v50, s29, v82 op_sel_hi:[0,0,1]
    v_fma_mix_f32 v54, v54, s29, v83 op_sel_hi:[0,0,1]
    v_fma_mix_f32 v43, v43, s29, v84 op_sel_hi:[0,0,1]
    v_fma_mix_f32 v47, v47, s29, v85 op_sel_hi:[0,0,1]
    v_fma_mix_f32 v51, v51, s29, v86 op_sel_hi:[0,0,1]
    v_fma_mix_f32 v55, v55, s29, v87 op_sel_hi:[0,0,1]
    v_exp_f32 v104, v40
    v_exp_f32 v105, v44
    v_exp_f32 v106, v48
    v_exp_f32 v107, v52
    v_exp_f32 v108, v41
    v_exp_f32 v109, v45
    v_exp_f32 v110, v49
    v_exp_f32 v111, v53
    v_pk_fma_f32 v[88:89], v[88:89], v[104:105], v[88:89]
    v_pk_fma_f32 v[90:91], v[90:91], v[106:107], v[90:91]
    v_pk_fma_f32 v[88:89], v[72:73], v[92:93], v[88:89]
    v_pk_fma_f32 v[90:91], v[74:75], v[94:95], v[90:91]
    v_pk_fma_f32 v[92:93], v[92:93], v[104:105], v[92:93]
    v_pk_fma_f32 v[94:95], v[94:95], v[106:107], v[94:95]
    v_pk_fma_f32 v[88:89], v[88:89], v[108:109], v[88:89]
    v_pk_fma_f32 v[90:91], v[90:91], v[110:111], v[90:91]
    v_pk_fma_f32 v[88:89], v[76:77], v[92:93], v[88:89]
    v_pk_fma_f32 v[90:91], v[78:79], v[94:95], v[90:91]
    v_pk_fma_f32 v[92:93], v[92:93], v[108:109], v[92:93]
    v_pk_fma_f32 v[94:95], v[94:95], v[110:111], v[94:95]
    v_exp_f32 v104, v42
    v_exp_f32 v105, v46
    v_exp_f32 v106, v50
    v_exp_f32 v107, v54
    v_exp_f32 v108, v43
    v_exp_f32 v109, v47
    v_exp_f32 v110, v51
    v_exp_f32 v111, v55
    v_rcp_f32 v92, v92
    v_rcp_f32 v93, v93
    v_rcp_f32 v94, v94
    v_rcp_f32 v95, v95
    v_pk_fma_f32 v[96:97], v[96:97], v[104:105], v[96:97]
    v_pk_fma_f32 v[98:99], v[98:99], v[106:107], v[98:99]
    v_pk_fma_f32 v[96:97], v[80:81], v[100:101], v[96:97]
    v_pk_fma_f32 v[98:99], v[82:83], v[102:103], v[98:99]
    v_pk_fma_f32 v[100:101], v[100:101], v[104:105], v[100:101]
    v_pk_fma_f32 v[102:103], v[102:103], v[106:107], v[102:103]
    v_pk_fma_f32 v[96:97], v[96:97], v[108:109], v[96:97]
    v_pk_fma_f32 v[98:99], v[98:99], v[110:111], v[98:99]
    v_pk_fma_f32 v[96:97], v[84:85], v[100:101], v[96:97]
    v_pk_fma_f32 v[98:99], v[86:87], v[102:103], v[98:99]
    v_pk_fma_f32 v[100:101], v[100:101], v[108:109], v[100:101]
    v_pk_fma_f32 v[102:103], v[102:103], v[110:111], v[102:103]
    v_pk_fma_f32 v[16:17], v[88:89], v[92:93], v[16:17]
    v_pk_fma_f32 v[18:19], v[90:91], v[94:95], v[18:19]
    v_rcp_f32 v100, v100
    v_rcp_f32 v101, v101
    v_rcp_f32 v102, v102
    v_rcp_f32 v103, v103
    s_nop 0
    v_pk_fma_f32 v[20:21], v[96:97], v[100:101], v[20:21]
    v_pk_fma_f32 v[22:23], v[98:99], v[102:103], v[22:23]
    s_sub_u32 s52, s52, 1
    s_cbranch_scc0 K2_QX
    s_call_b64 s[82:83], K2_EPI
    s_branch K2_QX
K2_QY:
    s_waitcnt lgkmcnt(0)
    v_mfma_f32_4x4x4_16b_bf16 v[40:43], v[14:15], v[112:113], v[24:27]
    v_mfma_f32_4x4x4_16b_bf16 v[44:47], v[14:15], v[114:115], v[28:31]
    v_mfma_f32_4x4x4_16b_bf16 v[48:51], v[14:15], v[116:117], v[32:35]
    v_mfma_f32_4x4x4_16b_bf16 v[52:55], v[14:15], v[118:119], v[36:39]
    v_lshlrev_b32_sdwa v7, 7, v6 dst_sel:DWORD dst_unused:UNUSED_PAD src0_sel:DWORD src1_sel:WORD_1
    v_lshlrev_b32_sdwa v8, 3, v6 dst_sel:DWORD dst_unused:UNUSED_PAD src0_sel:DWORD src1_sel:WORD_0
    s_add_u32 s48, s48, 128
    s_sub_u32 s49, s49, 1
    s_cbranch_scc1 K2_SWK2_QY0
K2_SWRK2_QY0:
    ds_read_b64 v[14:15], v8 offset:38400
    v_add_u32_dpp v104, v7, v2 quad_perm:[0,0,0,0] row_mask:0xf bank_mask:0xf
    v_add_u32_dpp v105, v7, v2 quad_perm:[1,1,1,1] row_mask:0xf bank_mask:0xf
    v_add_u32_dpp v106, v7, v2 quad_perm:[2,2,2,2] row_mask:0xf bank_mask:0xf
    v_add_u32_dpp v107, v7, v2 quad_perm:[3,3,3,3] row_mask:0xf bank_mask:0xf
    buffer_load_dwordx4 v[56:59], v104, s[36:39], 0 offen sc1
    buffer_load_dwordx4 v[60:63], v105, s[36:39], 0 offen sc1
    buffer_load_dwordx4 v[64:67], v106, s[36:39], 0 offen sc1
    buffer_load_dwordx4 v[68:71], v107, s[36:39], 0 offen sc1
    v_add_u32 v9, s48, v4
    ds_read_b32 v6, v9
    s_waitcnt vmcnt(4)
    v_fma_mix_f32 v40, v40, s29, v72 op_sel_hi:[0,0,1]
    v_fma_mix_f32 v44, v44, s29, v73 op_sel_hi:[0,0,1]
    v_fma_mix_f32 v48, v48, s29, v74 op_sel_hi:[0,0,1]
    v_fma_mix_f32 v52, v52, s29, v75 op_sel_hi:[0,0,1]
    v_fma_mix_f32 v41, v41, s29, v76 op_sel_hi:[0,0,1]
    v_fma_mix_f32 v45, v45, s29, v77 op_sel_hi:[0,0,1]
    v_fma_mix_f32 v49, v49, s29, v78 op_sel_hi:[0,0,1]
    v_fma_mix_f32 v53, v53, s29, v79 op_sel_hi:[0,0,1]
    v_fma_mix_f32 v42, v42, s29, v80 op_sel_hi:[0,0,1]
    v_fma_mix_f32 v46, v46, s29, v81 op_sel_hi:[0,0,1]
    v_fma_mix_f32 v50, v50, s29, v82 op_sel_hi:[0,0,1]
    v_fma_mix_f32 v54, v54, s29, v83 op_sel_hi:[0,0,1]
    v_fma_mix_f32 v43, v43, s29, v84 op_sel_hi:[0,0,1]
    v_fma_mix_f32 v47, v47, s29, v85 op_sel_hi:[0,0,1]
    v_fma_mix_f32 v51, v51, s29, v86 op_sel_hi:[0,0,1]
    v_fma_mix_f32 v55, v55, s29, v87 op_sel_hi:[0,0,1]
    v_exp_f32 v104, v40
    v_exp_f32 v105, v44
    v_exp_f32 v106, v48
    v_exp_f32 v107, v52
    v_exp_f32 v108, v41
    v_exp_f32 v109, v45
    v_exp_f32 v110, v49
    v_exp_f32 v111, v53
    v_pk_add_f32 v[104:105], v[104:105], 1.0 op_sel_hi:[1,0]
    v_pk_add_f32 v[106:107], v[106:107], 1.0 op_sel_hi:[1,0]
    v_pk_fma_f32 v[88:89], v[76:77], v[104:105], v[72:73]
    v_pk_fma_f32 v[90:91], v[78:79], v[106:107], v[74:75]
    v_pk_fma_f32 v[92:93], v[104:105], v[108:109], v[104:105]
    v_pk_fma_f32 v[94:95], v[106:107], v[110:111], v[106:107]
    v_pk_fma_f32 v[88:89], v[72:73], v[108:109], v[88:89]
    v_pk_fma_f32 v[90:91], v[74:75], v[110:111], v[90:91]
    v_exp_f32 v104, v42
    v_exp_f32 v105, v46
    v_exp_f32 v106, v50
    v_exp_f32 v107, v54
    v_exp_f32 v108, v43
    v_exp_f32 v109, v47
    v_exp_f32 v110, v51
    v_exp_f32 v111, v55
    v_pk_add_f32 v[104:105], v[104:105], 1.0 op_sel_hi:[1,0]
    v_pk_add_f32 v[106:107], v[106:107], 1.0 op_sel_hi:[1,0]
    v_pk_fma_f32 v[96:97], v[84:85], v[104:105], v[80:81]
    v_pk_fma_f32 v[98:99], v[86:87], v[106:107], v[82:83]
    v_pk_fma_f32 v[100:101], v[104:105], v[108:109], v[104:105]
    v_pk_fma_f32 v[102:103], v[106:107], v[110:111], v[106:107]
    v_pk_fma_f32 v[96:97], v[80:81], v[108:109], v[96:97]
    v_pk_fma_f32 v[98:99], v[82:83], v[110:111], v[98:99]
    s_sub_u32 s52, s52, 1
    s_cbranch_scc0 K2_QY_C
    s_call_b64 s[82:83], K2_EPIQ
    s_branch K2_QX
K2_QY_C:
    s_waitcnt lgkmcnt(0)
    v_mfma_f32_4x4x4_16b_bf16 v[40:43], v[14:15], v[112:113], v[24:27]
    v_mfma_f32_4x4x4_16b_bf16 v[44:47], v[14:15], v[114:115], v[28:31]
    v_mfma_f32_4x4x4_16b_bf16 v[48:51], v[14:15], v[116:117], v[32:35]
    v_mfma_f32_4x4x4_16b_bf16 v[52:55], v[14:15], v[118:119], v[36:39]
    v_lshlrev_b32_sdwa v7, 7, v6 dst_sel:DWORD dst_unused:UNUSED_PAD src0_sel:DWORD src1_sel:WORD_1
    v_lshlrev_b32_sdwa v8, 3, v6 dst_sel:DWORD dst_unused:UNUSED_PAD src0_sel:DWORD src1_sel:WORD_0
    s_add_u32 s48, s48, 128
    s_sub_u32 s49, s49, 1
    s_cbranch_scc1 K2_SWK2_QY1
K2_SWRK2_QY1:
    ds_read_b64 v[14:15], v8 offset:38400
    v_add_u32_dpp v104, v7, v2 quad_perm:[0,0,0,0] row_mask:0xf bank_mask:0xf
    v_add_u32_dpp v105, v7, v2 quad_perm:[1,1,1,1] row_mask:0xf bank_mask:0xf
    v_add_u32_dpp v106, v7, v2 quad_perm:[2,2,2,2] row_mask:0xf bank_mask:0xf
    v_add_u32_dpp v107, v7, v2 quad_perm:[3,3,3,3] row_mask:0xf bank_mask:0xf
    buffer_load_dwordx4 v[72:75], v104, s[36:39], 0 offen sc1
    buffer_load_dwordx4 v[76:79], v105, s[36:39], 0 offen sc1
    buffer_load_dwordx4 v[80:83], v106, s[36:39], 0 offen sc1
    buffer_load_dwordx4 v[84:87], v107, s[36:39], 0 offen sc1
    v_add_u32 v9, s48, v4
    ds_read_b32 v6, v9
    s_waitcnt vmcnt(4)
    v_fma_mix_f32 v40, v40, s29, v56 op_sel_hi:[0,0,1]
    v_fma_mix_f32 v44, v44, s29, v57 op_sel_hi:[0,0,1]
    v_fma_mix_f32 v48, v48, s29, v58 op_sel_hi:[0,0,1]
    v_fma_mix_f32 v52, v52, s29, v59 op_sel_hi:[0,0,1]
    v_fma_mix_f32 v41, v41, s29, v60 op_sel_hi:[0,0,1]
    v_fma_mix_f32 v45, v45, s29, v61 op_sel_hi:[0,0,1]
    v_fma_mix_f32 v49, v49, s29, v62 op_sel_hi:[0,0,1]
    v_fma_mix_f32 v53, v53, s29, v63 op_sel_hi:[0,0,1]
    v_fma_mix_f32 v42, v42, s29, v64 op_sel_hi:[0,0,1]
    v_fma_mix_f32 v46, v46, s29, v65 op_sel_hi:[0,0,1]
    v_fma_mix_f32 v50, v50, s29, v66 op_sel_hi:[0,0,1]
    v_fma_mix_f32 v54, v54, s29, v67 op_sel_hi:[0,0,1]
    v_fma_mix_f32 v43, v43, s29, v68 op_sel_hi:[0,0,1]
    v_fma_mix_f32 v47, v47, s29, v69 op_sel_hi:[0,0,1]
    v_fma_mix_f32 v51, v51, s29, v70 op_sel_hi:[0,0,1]
    v_fma_mix_f32 v55, v55, s29, v71 op_sel_hi:[0,0,1]
    v_exp_f32 v104, v40
    v_exp_f32 v105, v44
    v_exp_f32 v106, v48
    v_exp_f32 v107, v52
    v_exp_f32 v108, v41
    v_exp_f32 v109, v45
    v_exp_f32 v110, v49
    v_exp_f32 v111, v53
    v_pk_fma_f32 v[88:89], v[88:89], v[104:105], v[88:89]
    v_pk_fma_f32 v[90:91], v[90:91], v[106:107], v[90:91]
    v_pk_fma_f32 v[88:89], v[56:57], v[92:93], v[88:89]
    v_pk_fma_f32 v[90:91], v[58:59], v[94:95], v[90:91]
    v_pk_fma_f32 v[92:93], v[92:93], v[104:105], v[92:93]
    v_pk_fma_f32 v[94:95], v[94:95], v[106:107], v[94:95]
    v_pk_fma_f32 v[88:89], v[88:89], v[108:109], v[88:89]
    v_pk_fma_f32 v[90:91], v[90:91], v[110:111], v[90:91]
    v_pk_fma_f32 v[88:89], v[60:61], v[92:93], v[88:89]
    v_pk_fma_f32 v[90:91], v[62:63], v[94:95], v[90:91]
    v_pk_fma_f32 v[92:93], v[92:93], v[108:109], v[92:93]
    v_pk_fma_f32 v[94:95], v[94:95], v[110:111], v[94:95]
    v_exp_f32 v104, v42
    v_exp_f32 v105, v46
    v_exp_f32 v106, v50
    v_exp_f32 v107, v54
    v_exp_f32 v108, v43
    v_exp_f32 v109, v47
    v_exp_f32 v110, v51
    v_exp_f32 v111, v55
    v_rcp_f32 v92, v92
    v_rcp_f32 v93, v93
    v_rcp_f32 v94, v94
    v_rcp_f32 v95, v95
    v_pk_fma_f32 v[96:97], v[96:97], v[104:105], v[96:97]
    v_pk_fma_f32 v[98:99], v[98:99], v[106:107], v[98:99]
    v_pk_fma_f32 v[96:97], v[64:65], v[100:101], v[96:97]
    v_pk_fma_f32 v[98:99], v[66:67], v[102:103], v[98:99]
    v_pk_fma_f32 v[100:101], v[100:101], v[104:105], v[100:101]
    v_pk_fma_f32 v[102:103], v[102:103], v[106:107], v[102:103]
    v_pk_fma_f32 v[96:97], v[96:97], v[108:109], v[96:97]
    v_pk_fma_f32 v[98:99], v[98:99], v[110:111], v[98:99]
    v_pk_fma_f32 v[96:97], v[68:69], v[100:101], v[96:97]
    v_pk_fma_f32 v[98:99], v[70:71], v[102:103], v[98:99]
    v_pk_fma_f32 v[100:101], v[100:101], v[108:109], v[100:101]
    v_pk_fma_f32 v[102:103], v[102:103], v[110:111], v[102:103]
    v_pk_fma_f32 v[16:17], v[88:89], v[92:93], v[16:17]
    v_pk_fma_f32 v[18:19], v[90:91], v[94:95], v[18:19]
    v_rcp_f32 v100, v100
    v_rcp_f32 v101, v101
    v_rcp_f32 v102, v102
    v_rcp_f32 v103, v103
    s_nop 0
    v_pk_fma_f32 v[20:21], v[96:97], v[100:101], v[20:21]
    v_pk_fma_f32 v[22:23], v[98:99], v[102:103], v[22:23]
    s_sub_u32 s52, s52, 1
    s_cbranch_scc0 K2_QY
    s_call_b64 s[82:83], K2_EPI
    s_branch K2_QY
K2_LOOPS:
    s_waitcnt lgkmcnt(0)
    v_mfma_f32_4x4x4_16b_bf16 v[40:43], v[14:15], v[112:113], v[24:27]
    v_mfma_f32_4x4x4_16b_bf16 v[44:47], v[14:15], v[114:115], v[28:31]
    v_mfma_f32_4x4x4_16b_bf16 v[48:51], v[14:15], v[116:117], v[32:35]
    v_mfma_f32_4x4x4_16b_bf16 v[52:55], v[14:15], v[118:119], v[36:39]
    v_lshlrev_b32_sdwa v7, 7, v6 dst_sel:DWORD dst_unused:UNUSED_PAD src0_sel:DWORD src1_sel:WORD_1
    v_lshlrev_b32_sdwa v8, 3, v6 dst_sel:DWORD dst_unused:UNUSED_PAD src0_sel:DWORD src1_sel:WORD_0
    s_add_u32 s48, s48, 128
    s_sub_u32 s49, s49, 1
    s_cbranch_scc1 K2_SWLS0
K2_SWRLS0:
    ds_read_b64 v[14:15], v8 offset:38400
    v_add_u32_dpp v104, v7, v2 quad_perm:[0,0,0,0] row_mask:0xf bank_mask:0xf
    v_add_u32_dpp v105, v7, v2 quad_perm:[1,1,1,1] row_mask:0xf bank_mask:0xf
    v_add_u32_dpp v106, v7, v2 quad_perm:[2,2,2,2] row_mask:0xf bank_mask:0xf
    v_add_u32_dpp v107, v7, v2 quad_perm:[3,3,3,3] row_mask:0xf bank_mask:0xf
    buffer_load_dwordx4 v[72:75], v104, s[36:39], 0 offen sc1
    buffer_load_dwordx4 v[76:79], v105, s[36:39], 0 offen sc1
    buffer_load_dwordx4 v[80:83], v106, s[36:39], 0 offen sc1
    buffer_load_dwordx4 v[84:87], v107, s[36:39], 0 offen sc1
    v_add_u32 v9, s48, v4
    ds_read_b32 v6, v9
    s_waitcnt vmcnt(4)
    v_fma_mix_f32 v40, v40, s29, v56 op_sel_hi:[0,0,1]
    v_fma_mix_f32 v41, v41, s29, v60 op_sel_hi:[0,0,1]
    v_fma_mix_f32 v42, v42, s29, v64 op_sel_hi:[0,0,1]
    v_fma_mix_f32 v43, v43, s29, v68 op_sel_hi:[0,0,1]
    v_fma_mix_f32 v44, v44, s29, v57 op_sel_hi:[0,0,1]
    v_fma_mix_f32 v45, v45, s29, v61 op_sel_hi:[0,0,1]
    v_fma_mix_f32 v46, v46, s29, v65 op_sel_hi:[0,0,1]
    v_fma_mix_f32 v47, v47, s29, v69 op_sel_hi:[0,0,1]
    v_fma_mix_f32 v48, v48, s29, v58 op_sel_hi:[0,0,1]
    v_fma_mix_f32 v49, v49, s29, v62 op_sel_hi:[0,0,1]
    v_fma_mix_f32 v50, v50, s29, v66 op_sel_hi:[0,0,1]
    v_fma_mix_f32 v51, v51, s29, v70 op_sel_hi:[0,0,1]
    v_fma_mix_f32 v52, v52, s29, v59 op_sel_hi:[0,0,1]
    v_fma_mix_f32 v53, v53, s29, v63 op_sel_hi:[0,0,1]
    v_fma_mix_f32 v54, v54, s29, v67 op_sel_hi:[0,0,1]
    v_fma_mix_f32 v55, v55, s29, v71 op_sel_hi:[0,0,1]
    v_exp_f32 v40, v40
    v_exp_f32 v41, v41
    v_exp_f32 v42, v42
    v_exp_f32 v43, v43
    v_exp_f32 v44, v44
    v_exp_f32 v45, v45
    v_exp_f32 v46, v46
    v_exp_f32 v47, v47
    v_exp_f32 v48, v48
    v_exp_f32 v49, v49
    v_exp_f32 v50, v50
    v_exp_f32 v51, v51
    v_exp_f32 v52, v52
    v_exp_f32 v53, v53
    v_exp_f32 v54, v54
    v_exp_f32 v55, v55
    v_pk_add_f32 v[40:41], v[40:41], 1.0 op_sel_hi:[1,0]
    v_pk_add_f32 v[42:43], v[42:43], 1.0 op_sel_hi:[1,0]
    v_pk_add_f32 v[44:45], v[44:45], 1.0 op_sel_hi:[1,0]
    v_pk_add_f32 v[46:47], v[46:47], 1.0 op_sel_hi:[1,0]
    v_pk_add_f32 v[48:49], v[48:49], 1.0 op_sel_hi:[1,0]
    v_pk_add_f32 v[50:51], v[50:51], 1.0 op_sel_hi:[1,0]
    v_pk_add_f32 v[52:53], v[52:53], 1.0 op_sel_hi:[1,0]
    v_pk_add_f32 v[54:55], v[54:55], 1.0 op_sel_hi:[1,0]
    v_rcp_f32 v104, v40
    v_rcp_f32 v105, v44
    v_rcp_f32 v106, v48
    v_rcp_f32 v107, v52
    v_pk_fma_f32 v[16:17], v[56:57], v[104:105], v[16:17]
    v_pk_fma_f32 v[18:19], v[58:59], v[106:107], v[18:19]
    v_rcp_f32 v108, v41
    v_rcp_f32 v109, v45
    v_rcp_f32 v110, v49
    v_rcp_f32 v111, v53
    v_pk_fma_f32 v[16:17], v[60:61], v[108:109], v[16:17]
    v_pk_fma_f32 v[18:19], v[62:63], v[110:111], v[18:19]
    v_rcp_f32 v104, v42
    v_rcp_f32 v105, v46
    v_rcp_f32 v106, v50
    v_rcp_f32 v107, v54
    v_pk_fma_f32 v[20:21], v[64:65], v[104:105], v[20:21]
    v_pk_fma_f32 v[22:23], v[66:67], v[106:107], v[22:23]
    v_rcp_f32 v108, v43
    v_rcp_f32 v109, v47
    v_rcp_f32 v110, v51
    v_rcp_f32 v111, v55
    v_pk_fma_f32 v[20:21], v[68:69], v[108:109], v[20:21]
    v_pk_fma_f32 v[22:23], v[70:71], v[110:111], v[22:23]
    s_sub_u32 s52, s52, 1
    s_cbranch_scc0 K2_CS0
    s_call_b64 s[82:83], K2_EPI
K2_CS0:
    s_waitcnt lgkmcnt(0)
    v_mfma_f32_4x4x4_16b_bf16 v[40:43], v[14:15], v[112:113], v[24:27]
    v_mfma_f32_4x4x4_16b_bf16 v[44:47], v[14:15], v[114:115], v[28:31]
    v_mfma_f32_4x4x4_16b_bf16 v[48:51], v[14:15], v[116:117], v[32:35]
    v_mfma_f32_4x4x4_16b_bf16 v[52:55], v[14:15], v[118:119], v[36:39]
    v_lshlrev_b32_sdwa v7, 7, v6 dst_sel:DWORD dst_unused:UNUSED_PAD src0_sel:DWORD src1_sel:WORD_1
    v_lshlrev_b32_sdwa v8, 3, v6 dst_sel:DWORD dst_unused:UNUSED_PAD src0_sel:DWORD src1_sel:WORD_0
    s_add_u32 s48, s48, 128
    s_sub_u32 s49, s49, 1
    s_cbranch_scc1 K2_SWLS1
K2_SWRLS1:
    ds_read_b64 v[14:15], v8 offset:38400
    v_add_u32_dpp v104, v7, v2 quad_perm:[0,0,0,0] row_mask:0xf bank_mask:0xf
    v_add_u32_dpp v105, v7, v2 quad_perm:[1,1,1,1] row_mask:0xf bank_mask:0xf
    v_add_u32_dpp v106, v7, v2 quad_perm:[2,2,2,2] row_mask:0xf bank_mask:0xf
    v_add_u32_dpp v107, v7, v2 quad_perm:[3,3,3,3] row_mask:0xf bank_mask:0xf
    buffer_load_dwordx4 v[56:59], v104, s[36:39], 0 offen sc1
    buffer_load_dwordx4 v[60:63], v105, s[36:39], 0 offen sc1
    buffer_load_dwordx4 v[64:67], v106, s[36:39], 0 offen sc1
    buffer_load_dwordx4 v[68:71], v107, s[36:39], 0 offen sc1
    v_add_u32 v9, s48, v4
    ds_read_b32 v6, v9
    s_waitcnt vmcnt(4)
    v_fma_mix_f32 v40, v40, s29, v72 op_sel_hi:[0,0,1]
    v_fma_mix_f32 v41, v41, s29, v76 op_sel_hi:[0,0,1]
    v_fma_mix_f32 v42, v42, s29, v80 op_sel_hi:[0,0,1]
    v_fma_mix_f32 v43, v43, s29, v84 op_sel_hi:[0,0,1]
    v_fma_mix_f32 v44, v44, s29, v73 op_sel_hi:[0,0,1]
    v_fma_mix_f32 v45, v45, s29, v77 op_sel_hi:[0,0,1]
    v_fma_mix_f32 v46, v46, s29, v81 op_sel_hi:[0,0,1]
    v_fma_mix_f32 v47, v47, s29, v85 op_sel_hi:[0,0,1]
    v_fma_mix_f32 v48, v48, s29, v74 op_sel_hi:[0,0,1]
    v_fma_mix_f32 v49, v49, s29, v78 op_sel_hi:[0,0,1]
    v_fma_mix_f32 v50, v50, s29, v82 op_sel_hi:[0,0,1]
    v_fma_mix_f32 v51, v51, s29, v86 op_sel_hi:[0,0,1]
    v_fma_mix_f32 v52, v52, s29, v75 op_sel_hi:[0,0,1]
    v_fma_mix_f32 v53, v53, s29, v79 op_sel_hi:[0,0,1]
    v_fma_mix_f32 v54, v54, s29, v83 op_sel_hi:[0,0,1]
    v_fma_mix_f32 v55, v55, s29, v87 op_sel_hi:[0,0,1]
    v_exp_f32 v40, v40
    v_exp_f32 v41, v41
    v_exp_f32 v42, v42
    v_exp_f32 v43, v43
    v_exp_f32 v44, v44
    v_exp_f32 v45, v45
    v_exp_f32 v46, v46
    v_exp_f32 v47, v47
    v_exp_f32 v48, v48
    v_exp_f32 v49, v49
    v_exp_f32 v50, v50
    v_exp_f32 v51, v51
    v_exp_f32 v52, v52
    v_exp_f32 v53, v53
    v_exp_f32 v54, v54
    v_exp_f32 v55, v55
    v_pk_add_f32 v[40:41], v[40:41], 1.0 op_sel_hi:[1,0]
    v_pk_add_f32 v[42:43], v[42:43], 1.0 op_sel_hi:[1,0]
    v_pk_add_f32 v[44:45], v[44:45], 1.0 op_sel_hi:[1,0]
    v_pk_add_f32 v[46:47], v[46:47], 1.0 op_sel_hi:[1,0]
    v_pk_add_f32 v[48:49], v[48:49], 1.0 op_sel_hi:[1,0]
    v_pk_add_f32 v[50:51], v[50:51], 1.0 op_sel_hi:[1,0]
    v_pk_add_f32 v[52:53], v[52:53], 1.0 op_sel_hi:[1,0]
    v_pk_add_f32 v[54:55], v[54:55], 1.0 op_sel_hi:[1,0]
    v_rcp_f32 v104, v40
    v_rcp_f32 v105, v44
    v_rcp_f32 v106, v48
    v_rcp_f32 v107, v52
    v_pk_fma_f32 v[16:17], v[72:73], v[104:105], v[16:17]
    v_pk_fma_f32 v[18:19], v[74:75], v[106:107], v[18:19]
    v_rcp_f32 v108, v41
    v_rcp_f32 v109, v45
    v_rcp_f32 v110, v49
    v_rcp_f32 v111, v53
    v_pk_fma_f32 v[16:17], v[76:77], v[108:109], v[16:17]
    v_pk_fma_f32 v[18:19], v[78:79], v[110:111], v[18:19]
    v_rcp_f32 v104, v42
    v_rcp_f32 v105, v46
    v_rcp_f32 v106, v50
    v_rcp_f32 v107, v54
    v_pk_fma_f32 v[20:21], v[80:81], v[104:105], v[20:21]
    v_pk_fma_f32 v[22:23], v[82:83], v[106:107], v[22:23]
    v_rcp_f32 v108, v43
    v_rcp_f32 v109, v47
    v_rcp_f32 v110, v51
    v_rcp_f32 v111, v55
    v_pk_fma_f32 v[20:21], v[84:85], v[108:109], v[20:21]
    v_pk_fma_f32 v[22:23], v[86:87], v[110:111], v[22:23]
    s_sub_u32 s52, s52, 1
    s_cbranch_scc0 K2_LOOPS
    s_call_b64 s[82:83], K2_EPI
    s_branch K2_LOOPS
K2_EPIQ:
    v_rcp_f32 v92, v92
    v_rcp_f32 v93, v93
    v_rcp_f32 v94, v94
    v_rcp_f32 v95, v95
    v_rcp_f32 v100, v100
    v_rcp_f32 v101, v101
    v_rcp_f32 v102, v102
    v_rcp_f32 v103, v103
    v_pk_fma_f32 v[16:17], v[88:89], v[92:93], v[16:17]
    v_pk_fma_f32 v[18:19], v[90:91], v[94:95], v[18:19]
    v_pk_fma_f32 v[20:21], v[96:97], v[100:101], v[20:21]
    v_pk_fma_f32 v[22:23], v[98:99], v[102:103], v[22:23]
K2_EPI:
    v_pk_mul_f32 v[40:41], v[16:17], s[56:57]
    v_pk_mul_f32 v[42:43], v[18:19], s[56:57]
    v_pk_mul_f32 v[44:45], v[20:21], s[56:57]
    v_pk_mul_f32 v[46:47], v[22:23], s[56:57]
    v_exp_f32 v40, v40
    v_exp_f32 v41, v41
    v_exp_f32 v42, v42
    v_exp_f32 v43, v43
    v_exp_f32 v44, v44
    v_exp_f32 v45, v45
    v_exp_f32 v46, v46
    v_exp_f32 v47, v47
    s_nop 0
    v_pk_add_f32 v[40:41], v[40:41], 1.0 op_sel_hi:[1,0]
    v_pk_add_f32 v[42:43], v[42:43], 1.0 op_sel_hi:[1,0]
    v_pk_add_f32 v[44:45], v[44:45], 1.0 op_sel_hi:[1,0]
    v_pk_add_f32 v[46:47], v[46:47], 1.0 op_sel_hi:[1,0]
    v_rcp_f32 v40, v40
    v_rcp_f32 v41, v41
    v_rcp_f32 v42, v42
    v_rcp_f32 v43, v43
    v_rcp_f32 v44, v44
    v_rcp_f32 v45, v45
    v_rcp_f32 v46, v46
    v_rcp_f32 v47, v47
    s_nop 0
    v_pk_mul_f32 v[40:41], v[40:41], v[16:17]
    v_pk_mul_f32 v[42:43], v[42:43], v[18:19]
    v_pk_mul_f32 v[44:45], v[44:45], v[20:21]
    v_pk_mul_f32 v[46:47], v[46:47], v[22:23]
    v_cvt_pk_bf16_f32 v40, v40, v41
    v_cvt_pk_bf16_f32 v41, v42, v43
    v_cvt_pk_bf16_f32 v42, v44, v45
    v_cvt_pk_bf16_f32 v43, v46, v47
    v_xor_b32 v9, v12, v2
    v_xor_b32 v106, v13, v2
    v_add_u32 v9, 112640, v9
    v_add_u32 v106, 112640, v106
    ds_read_b128 v[16:19], v9
    ds_read_b128 v[20:23], v106
    v_lshrrev_b32 v104, 7, v10
    v_lshrrev_b32 v105, 7, v11
    v_lshl_add_u32 v104, v104, 8, v5
    v_lshl_add_u32 v105, v105, 8, v5
    v_cmp_gt_u32 vcc, 50048, v10
    s_mov_b64 exec, vcc
    buffer_store_dwordx2 v[40:41], v104, s[40:43], s91 offen nt
    s_mov_b64 exec, -1
    v_cmp_gt_u32 vcc, 50048, v11
    s_mov_b64 exec, vcc
    buffer_store_dwordx2 v[42:43], v105, s[40:43], s91 offen nt
    s_mov_b64 exec, -1
    s_cmp_eq_u32 s53, 0
    s_cbranch_scc1 K2_FIN
    s_sub_u32 s52, s53, 1
    s_mov_b32 s53, 0
    v_mov_b32 v10, v12
    v_mov_b32 v11, v13
    s_waitcnt lgkmcnt(0)
    v_cvt_f32_f16 v24, v16
    v_cvt_f32_f16 v26, v20
    v_cvt_f32_f16 v28, v17
    v_cvt_f32_f16 v30, v21
    v_cvt_f32_f16 v32, v18
    v_cvt_f32_f16 v34, v22
    v_cvt_f32_f16 v36, v19
    v_cvt_f32_f16 v38, v23
    v_mov_b32 v25, v24
    v_mov_b32 v27, v26
    v_mov_b32 v29, v28
    v_mov_b32 v31, v30
    v_mov_b32 v33, v32
    v_mov_b32 v35, v34
    v_mov_b32 v37, v36
    v_mov_b32 v39, v38
    s_setpc_b64 s[82:83]
K2_FIN:
    s_endpgm
K2_SWF0:
    s_mov_b32 s48, s50
    s_mov_b32 s49, s51
    s_mov_b32 s50, 37888
    s_mov_b32 s51, 100
    s_branch K2_SWRF0
K2_SWK2_QX0:
    s_mov_b32 s48, s50
    s_mov_b32 s49, s51
    s_mov_b32 s50, 37888
    s_mov_b32 s51, 100
    s_branch K2_SWRK2_QX0
K2_SWK2_QX1:
    s_mov_b32 s48, s50
    s_mov_b32 s49, s51
    s_mov_b32 s50, 37888
    s_mov_b32 s51, 100
    s_branch K2_SWRK2_QX1
K2_SWK2_QY0:
    s_mov_b32 s48, s50
    s_mov_b32 s49, s51
    s_mov_b32 s50, 37888
    s_mov_b32 s51, 100
    s_branch K2_SWRK2_QY0
K2_SWK2_QY1:
    s_mov_b32 s48, s50
    s_mov_b32 s49, s51
    s_mov_b32 s50, 37888
    s_mov_b32 s51, 100
    s_branch K2_SWRK2_QY1
K2_SWLS0:
    s_mov_b32 s48, s50
    s_mov_b32 s49, s51
    s_mov_b32 s50, 37888
    s_mov_b32 s51, 100
    s_branch K2_SWRLS0
K2_SWLS1:
    s_mov_b32 s48, s50
    s_mov_b32 s49, s51
    s_mov_b32 s50, 37888
    s_mov_b32 s51, 100
    s_branch K2_SWRLS1
K2_TAIL:
    v_lshlrev_b32 v64, 3, v1
K2_TAIL_LOOP:
    s_ff1_i32_b64 s25, s[88:89]
    s_bitset0_b64 s[88:89], s25
    v_readlane_b32 s26, v104, s25
    s_add_u32 s25, s25, s28
    s_mul_i32 s25, s25, 3200
    s_and_b32 s27, s26, 0xffff
    s_add_u32 s25, s25, s27
    s_add_u32 s25, s25, 64
    s_sub_u32 s25, s25, s30
    s_lshr_b32 s26, s26, 16
    s_sub_u32 s26, s26, 64
    s_add_u32 s27, s30, s26
    s_cmp_gt_u32 s27, 63
    s_cbranch_scc1 K2_TAILF
    s_bfm_b64 s[54:55], s26, s30
    s_or_b64 s[80:81], s[80:81], s[54:55]
    s_mov_b32 s30, s27
    s_lshl_b32 s26, s25, 2
    s_add_u32 s26, s26, 33554432
    s_lshl_b32 s27, s25, 3
    s_add_u32 s27, s27, 35651584
    s_mov_b64 exec, s[54:55]
    buffer_load_dword v36, v65, s[32:35], s26 offen sc1
    buffer_load_dwordx2 v[70:71], v64, s[32:35], s27 offen sc1
    s_mov_b64 exec, -1
    s_cmp_lg_u64 s[88:89], 0
    s_cbranch_scc1 K2_TAIL_LOOP
    s_branch K2_TAILR
K2_TAILF:
    s_mov_b32 s31, 1
    s_branch K2_TAILR
K2_FALLBACK:
    s_waitcnt vmcnt(0) lgkmcnt(0)
    s_mov_b32 s56, 0xbfb8aa3b
    s_mov_b32 s57, 0xbfb8aa3b
    s_barrier
    v_lshlrev_b32 v51, 4, v0
    v_add_u32 v51, 38400, v51
    v_mov_b32 v56, 0
    v_mov_b32 v57, 0
    v_mov_b32 v58, 0
    v_mov_b32 v59, 0
    ds_write_b128 v51, v[56:59] offset:0
    ds_write_b128 v51, v[56:59] offset:16384
    ds_write_b128 v51, v[56:59] offset:32768
    ds_write_b128 v51, v[56:59] offset:49152
    s_waitcnt lgkmcnt(0)
    s_barrier
    s_mov_b32 s64, s10
    s_mov_b32 s65, s11
    s_mov_b32 s66, 1600000
    s_mov_b32 s67, 0x20000
    s_mov_b32 s44, s8
    s_mov_b32 s45, s9
    s_mov_b32 s46, 1600000
    s_mov_b32 s47, 0x20000
    s_mov_b32 s60, s6
    s_mov_b32 s61, s7
    s_mov_b32 s62, 3200000
    s_mov_b32 s63, 0x20000
    s_mul_i32 s28, s24, 391
    s_mul_i32 s27, s24, 50048
    s_lshl_b32 s25, s22, 5
    v_lshrrev_b32 v51, 1, v3
K2_FB_LOOP:
    s_lshl_b32 s26, s25, 1
    buffer_load_dword v52, v51, s[64:67], s25 offen
    buffer_load_dword v53, v51, s[44:47], s25 offen
    buffer_load_dwordx2 v[54:55], v3, s[60:63], s26 offen
    s_waitcnt vmcnt(0)
    v_subrev_u32 v52, s28, v52
    v_cmp_gt_u32 vcc, 391, v52
    s_mov_b64 exec, vcc
    s_cbranch_execz K2_FB_NEXT
    v_lshl_add_u32 v53, v53, 7, v2
    v_and_b32 v56, 7, v52
    v_lshlrev_b32 v56, 4, v56
    v_lshl_add_u32 v52, v52, 7, v2
    v_xor_b32 v56, v56, v52
    v_add_u32 v56, 112640, v56
    buffer_load_dwordx4 v[16:19], v53, s[36:39], 0 offen sc1
    ds_read_b128 v[20:23], v56
    v_add_u32 v52, 38400, v52
    s_waitcnt vmcnt(0) lgkmcnt(0)
    v_cvt_f32_f16 v20, v20
    v_cvt_f32_f16 v21, v21
    v_cvt_f32_f16 v22, v22
    v_cvt_f32_f16 v23, v23
    v_dot2_f32_bf16 v20, v54, v112, v20
    v_dot2_f32_bf16 v21, v54, v114, v21
    v_dot2_f32_bf16 v22, v54, v116, v22
    v_dot2_f32_bf16 v23, v54, v118, v23
    v_dot2_f32_bf16 v20, v55, v113, v20
    v_dot2_f32_bf16 v21, v55, v115, v21
    v_dot2_f32_bf16 v22, v55, v117, v22
    v_dot2_f32_bf16 v23, v55, v119, v23
    s_nop 3
    v_fma_mix_f32 v20, v20, s29, v16 op_sel_hi:[0,0,1]
    v_fma_mix_f32 v21, v21, s29, v17 op_sel_hi:[0,0,1]
    v_fma_mix_f32 v22, v22, s29, v18 op_sel_hi:[0,0,1]
    v_fma_mix_f32 v23, v23, s29, v19 op_sel_hi:[0,0,1]
    v_exp_f32 v20, v20
    v_exp_f32 v21, v21
    v_exp_f32 v22, v22
    v_exp_f32 v23, v23
    s_nop 0
    v_add_f32 v20, 1.0, v20
    v_add_f32 v21, 1.0, v21
    v_add_f32 v22, 1.0, v22
    v_add_f32 v23, 1.0, v23
    v_rcp_f32 v20, v20
    v_rcp_f32 v21, v21
    v_rcp_f32 v22, v22
    v_rcp_f32 v23, v23
    s_nop 0
    v_mul_f32 v20, v20, v16
    v_mul_f32 v21, v21, v17
    v_mul_f32 v22, v22, v18
    v_mul_f32 v23, v23, v19
    ds_add_f32 v52, v20 offset:0
    ds_add_f32 v52, v21 offset:4
    ds_add_f32 v52, v22 offset:8
    ds_add_f32 v52, v23 offset:12
K2_FB_NEXT:
    s_mov_b64 exec, -1
    s_add_u32 s25, s25, 512
    s_cmp_lt_u32 s25, 1600000
    s_cbranch_scc1 K2_FB_LOOP
    s_waitcnt lgkmcnt(0)
    s_barrier
    s_lshl_b32 s25, s22, 10
    v_lshlrev_b32 v51, 4, v3
K2_FB_OUT:
    v_add_u32 v52, s25, v51
    v_add_u32 v53, v52, v2
    v_lshlrev_b32 v56, 1, v3
    v_xor_b32 v56, v56, v53
    v_min_u32 v56, 51184, v56
    v_add_u32 v56, 112640, v56
    ds_read_b128 v[16:19], v56
    v_add_u32 v53, 38400, v53
    ds_read_b128 v[20:23], v53
    s_waitcnt vmcnt(0) lgkmcnt(0)
    v_add_f32 v16, v16, v20
    v_add_f32 v17, v17, v21
    v_add_f32 v18, v18, v22
    v_add_f32 v19, v19, v23
    v_pk_mul_f32 v[24:25], v[16:17], s[56:57]
    v_pk_mul_f32 v[26:27], v[18:19], s[56:57]
    v_exp_f32 v24, v24
    v_exp_f32 v25, v25
    v_exp_f32 v26, v26
    v_exp_f32 v27, v27
    s_nop 0
    v_pk_add_f32 v[24:25], v[24:25], 1.0 op_sel_hi:[1,0]
    v_pk_add_f32 v[26:27], v[26:27], 1.0 op_sel_hi:[1,0]
    v_rcp_f32 v24, v24
    v_rcp_f32 v25, v25
    v_rcp_f32 v26, v26
    v_rcp_f32 v27, v27
    s_nop 0
    v_pk_mul_f32 v[24:25], v[24:25], v[16:17]
    v_pk_mul_f32 v[26:27], v[26:27], v[18:19]
    v_cvt_pk_bf16_f32 v24, v24, v25
    v_cvt_pk_bf16_f32 v25, v26, v27
    v_lshl_add_u32 v53, v52, 1, v5
    v_cmp_gt_u32 vcc, 50048, v52
    s_mov_b64 exec, vcc
    buffer_store_dwordx2 v[24:25], v53, s[40:43], s91 offen nt
    s_mov_b64 exec, -1
    s_add_u32 s25, s25, 16384
    s_cmp_lt_u32 s25, 50048
    s_cbranch_scc1 K2_FB_OUT
K2_END:
    s_endpgm
.section .rodata,"a"
.p2align 6
.amdhsa_kernel gather_scatter__edge_featured_mpnn_egc__graph_kernel
  .amdhsa_next_free_vgpr 128
  .amdhsa_next_free_sgpr 102
  .amdhsa_accum_offset 128
  .amdhsa_group_segment_fixed_size 0
  .amdhsa_kernarg_size 80
  .amdhsa_user_sgpr_count 2
  .amdhsa_user_sgpr_kernarg_segment_ptr 1
  .amdhsa_system_sgpr_workgroup_id_x 1
  .amdhsa_fp16_overflow 1
.end_amdhsa_kernel
```
